```python
import torch

def _softmax(x, axis=-1):
    return torch.softmax(x, dim=axis)
def _gelu(x):
    return torch.nn.functional.gelu(x, approximate="tanh")
def _silu(x):
    return torch.nn.functional.silu(x)
def _sigmoid(x):
    return torch.sigmoid(x)
def _layernorm(x, axis=-1, eps=1e-5):
    m = x.mean(dim=axis, keepdim=True)
    v = x.var(dim=axis, keepdim=True, unbiased=False)
    return (x - m) / torch.sqrt(v + eps)
def _scatter_add(tgt, idx, src, axis=0):
    return tgt.clone().index_add_(axis, idx, src)
def _segment_sum(src, seg, n):
    out = torch.zeros((n,) + src.shape[1:], dtype=src.dtype)
    return out.index_add_(0, seg, src)
def _pad(x, pw):
    flat = tuple(v for pair in reversed(pw) for v in pair)
    return torch.nn.functional.pad(x, flat)

kernel_name = 'standalone__gqa_block_cached__near_ridge'

def setup_inputs():

    _w = (lambda a: (lambda t: t.to(torch.bfloat16) if t.is_floating_point() else t)(torch.as_tensor(a)))
    B, Sq, D = 16, 32, 640
    Hq, Hkv, Sk, Dh = 32, 32, 32, 192
    assert Hq % Hkv == 0, (Hq, Hkv)
    return {
        "x": _w((lambda *s: torch.randn(*s, dtype=torch.bfloat16) * 0.8)(B, Sq, D)),
        "k_cache": _w((lambda *s: torch.randn(*s, dtype=torch.bfloat16) * 0.8)(B, Hkv, Sk, Dh)),
        "v_cache": _w((lambda *s: torch.randn(*s, dtype=torch.bfloat16) * 0.05)(B, Hkv, Sk, Dh)),
        "wq": _w((lambda *s: torch.randn(*s, dtype=torch.bfloat16) * 0.8)(D, Hq * Dh) * (D ** -0.5)),
        "wo": _w((lambda *s: torch.randn(*s, dtype=torch.bfloat16) * 0.05)(Hq * Dh, D) * ((Hq * Dh) ** -0.5)),
    }

def reference(x, k_cache, v_cache, wq, wo):
    B, Sq, D = x.shape
    Hq, Dh = 32, 192
    Hkv = k_cache.shape[1]
    rep = Hq // Hkv
    q = (lambda x, *d: x.permute(*d))((x @ wq).reshape(B, Sq, Hq, Dh), 0, 2, 1, 3)
    k = (lambda x, n, axis: torch.repeat_interleave(x, n, dim=axis))(k_cache, rep, axis=1)
    v = (lambda x, n, axis: torch.repeat_interleave(x, n, dim=axis))(v_cache, rep, axis=1)
    scores = torch.einsum("bhqd,bhkd->bhqk", q, k) * (Dh ** -0.5)
    p = _softmax(scores, axis=-1)
    o = torch.einsum("bhqk,bhkd->bhqd", p, v)
    return (lambda x, *d: x.permute(*d))(o, 0, 2, 1, 3).reshape(B, Sq, Hq * Dh) @ wo
```

```asm
; @launch grid=(256,1,1) block=(256,1,1) lds=163840
.amdgcn_target "amdgcn-amd-amdhsa--gfx950"
.text
.p2align 12
.text
.globl standalone__gqa_block_cached__near_ridge_kernel
.p2align 8
.type standalone__gqa_block_cached__near_ridge_kernel,@function
standalone__gqa_block_cached__near_ridge_kernel:
    s_cmp_ge_u32 s2, 256
    s_cbranch_scc1 DONE
    s_lshr_b32 s35, s2, 7
    s_lshl_b32 s40, s35, 4
    s_lshl_b32 s41, s35, 3
    s_add_u32 s41, s41, 24
    s_load_dwordx2 s[8:9], s[0:1], s41
    s_load_dwordx2 s[4:5], s[0:1], s40
    s_getpc_b64 s[94:95]
PC_REF:
    s_lshr_b32 s3, s2, 3
    s_mulk_i32 s3, 1536
    v_mul_u32_u24 v5, 6, v0
    v_and_b32 v6, 63, v0
    v_mul_u32_u24 v6, 122, v6
    v_add3_u32 v5, v5, v6, s3
    v_min_u32 v5, DONE-PC_REF, v5
    s_mov_b64 exec, 7
    global_load_dword v23, v5, s[94:95]
    s_mov_b64 exec, -1
    v_lshrrev_b32 v1, 6, v0
    v_and_b32 v0, 63, v0
    v_readfirstlane_b32 s32, v1
    s_and_b32 s28, s2, 7
    s_bfe_u32 s29, s2, 0x20003
    s_bfe_u32 s30, s2, 0x20005
    s_add_u32 s31, s29, s30
    s_and_b32 s31, s31, 3
    s_cmp_eq_u32 s35, 0
    s_movk_i32 s42, 1280
    s_cselect_b32 s47, 12288, s42
    s_cselect_b32 s48, s42, 384
    s_mov_b32 s42, 6291456
    s_cselect_b32 s6, 655360, s42
    s_mov_b32 s7, 0x20000
    s_mov_b32 s10, 7868416
    s_mov_b32 s11, 0x20000
    v_lshrrev_b32 v2, 3, v0
    v_and_b32 v3, 7, v0
    v_lshrrev_b32 v4, 4, v0
    s_and_b32 s43, s31, 1
    s_lshl_b32 s40, s43, 5
    v_lshl_add_u32 v5, v1, 3, v2
    v_add_u32 v5, s40, v5
    v_mul_lo_u32 v5, v5, s47
    v_and_b32 v6, 2, v2
    v_xor_b32 v6, v6, v3
    v_and_b32 v21, 1, v1
    v_lshlrev_b32 v21, 2, v21
    v_xor_b32 v6, v6, v21
    v_lshl_add_u32 v5, v6, 4, v5
    v_add_u32 v8, 4096, v5
    v_add_u32 v9, 3200, v5
    v_add_u32 v10, 2304, v5
    s_lshl_b32 s40, s43, 1
    s_sub_u32 s40, 1, s40
    s_mul_i32 s41, s40, s47
    s_lshl_b32 s41, s41, 5
    v_add_u32 v11, s41, v8
    v_add_u32 v12, s41, v9
    v_add_u32 v13, s41, v10
    v_mul_lo_u32 v5, v2, s48
    v_xor_b32 v6, v3, v4
    v_lshl_add_u32 v14, v6, 4, v5
    v_xor_b32 v15, 64, v14
    s_lshl_b32 s42, s48, 3
    s_sub_u32 s42, s42, 1024
    v_add_u32 v15, s42, v15
    s_cmp_eq_u32 s35, 0
    s_mov_b32 s42, 393216
    s_cselect_b32 s44, 40960, s42
    s_mul_i32 s41, s43, s44
    s_lshl_b32 s41, s41, 1
    v_add_u32 v14, s41, v14
    v_add_u32 v15, s41, v15
    s_mul_i32 s41, s40, s44
    s_lshl_b32 s41, s41, 1
    v_add_u32 v16, s41, v14
    v_add_u32 v17, s41, v15
    s_lshr_b32 s41, s32, 1
    s_lshl_b32 s33, s30, 2
    s_add_u32 s33, s33, s41
    s_mul_i32 s45, s33, s44
    s_and_b32 s41, s32, 1
    s_mul_i32 s41, s41, s48
    s_lshl_b32 s41, s41, 4
    s_add_u32 s45, s45, s41
    s_lshl_b32 s34, s28, 2
    s_lshl_b32 s41, s43, 2
    s_add_u32 s42, s41, s32
    s_mul_i32 s38, s42, 3072
    s_lshl_b32 s39, s42, 11
    s_add_u32 s39, s39, 24576
    s_xor_b32 s42, s42, 4
    s_mul_i32 s47, s42, 3072
    s_lshl_b32 s48, s42, 11
    s_add_u32 s48, s48, 24576
    s_cmp_eq_u32 s35, 0
    s_cbranch_scc0 ROLE_B
ROLE_A:
    s_mov_b32 s36, 0x56341290
    s_mov_b32 s37, 0x78
    s_cmp_eq_u32 s31, 1
    s_cselect_b32 s36, 0x56341290, s36
    s_cselect_b32 s37, 0x78, s37
    s_cmp_eq_u32 s31, 2
    s_cselect_b32 s36, 0x74523019, s36
    s_cselect_b32 s37, 0x86, s37
    s_cmp_eq_u32 s31, 3
    s_cselect_b32 s36, 0x74523019, s36
    s_cselect_b32 s37, 0x86, s37
    s_add_u32 s34, s34, s29
    s_mul_i32 s44, s34, 384
    s_bfe_u32 s40, s36, 0x40000
    s_add_u32 s40, s40, s28
    s_cmp_ge_u32 s40, 10
    s_cselect_b32 s41, 10, 0
    s_sub_u32 s40, s40, s41
    s_mul_i32 s64, s40, 786432
    s_add_u32 s64, s64, s44
    s_lshl_b32 s40, s40, 7
    s_add_u32 s65, s40, s45
    s_waitcnt lgkmcnt(0)
    s_sub_u32 s8, s8, 4096
    s_subb_u32 s9, s9, 0
    s_add_u32 m0, s38, 0
    s_nop 0
    buffer_load_dwordx4 v8, s[8:11], s64 offen lds
    buffer_load_dwordx4 v9, s[8:11], s64 offen offset:1024 lds
    buffer_load_dwordx4 v10, s[8:11], s64 offen offset:2048 lds
    s_add_u32 m0, s39, 0
    s_nop 0
    buffer_load_dwordx4 v14, s[4:7], s65 offen lds
    buffer_load_dwordx4 v15, s[4:7], s65 offen offset:1024 lds
    s_add_u32 m0, s47, 0
    s_nop 0
    buffer_load_dwordx4 v11, s[8:11], s64 offen lds
    buffer_load_dwordx4 v12, s[8:11], s64 offen offset:1024 lds
    buffer_load_dwordx4 v13, s[8:11], s64 offen offset:2048 lds
    s_add_u32 m0, s48, 0
    s_nop 0
    buffer_load_dwordx4 v16, s[4:7], s65 offen lds
    buffer_load_dwordx4 v17, s[4:7], s65 offen offset:1024 lds
    s_add_u32 m0, s38, 40960
    s_load_dwordx2 s[12:13], s[0:1], 8
    s_load_dwordx2 s[20:21], s[0:1], 40
    s_load_dwordx2 s[24:25], s[0:1], 48
    s_load_dwordx2 s[16:17], s[0:1], 56
    s_mov_b32 s14, 6291456
    s_mov_b32 s15, 0x20000
    s_mov_b32 s18, 268435456
    s_mov_b32 s19, 0x20000
    s_mov_b32 s22, 655360
    s_mov_b32 s23, 0x20000
    s_mov_b32 s26, 256
    s_mov_b32 s27, 0x20000
    s_mov_b32 s46, 200000
    s_waitcnt lgkmcnt(0)
    s_and_b32 s50, s32, 1
    s_lshr_b32 s51, s32, 1
    s_lshl_b32 s40, s30, 2
    s_add_u32 s40, s40, s51
    s_lshl_b32 s40, s40, 5
    s_add_u32 s40, s40, s34
    s_lshl_b32 s52, s40, 1
    s_add_u32 s52, s52, s50
    s_lshl_b32 s52, s52, 10
    v_mul_u32_u24 v5, 3072, v4
    v_and_b32 v21, 3, v0
    v_lshl_add_u32 v5, v21, 3, v5
    v_lshrrev_b32 v6, 5, v0
    v_mul_u32_u24 v6, 6144, v6
    v_lshl_add_u32 v6, v21, 3, v6
    v_bfe_u32 v1, v0, 2, 2
    v_lshl_add_u32 v5, v1, 7, v5
    v_lshl_add_u32 v6, v1, 6, v6
    v_bfe_u32 v1, v0, 3, 2
    v_lshl_add_u32 v5, v1, 5, v5
    v_bfe_u32 v1, v0, 4, 1
    v_lshl_add_u32 v6, v1, 9, v6
    v_lshlrev_b32 v20, 4, v0
    v_mov_b32 v160, -1
    v_mov_b32 v161, -1
    v_mov_b32 v162, -1
    v_mov_b32 v163, -1
    s_add_u32 s61, s52, 131072
    v_add_u32 v56, 8388608, v20
    s_mul_i32 s49, s40, 12288
    s_mul_i32 s41, s50, 6144
    s_add_u32 s49, s49, s41
    s_add_u32 s55, s49, 0
    s_add_u32 s56, s49, 128
    s_add_u32 s57, s49, 256
    s_add_u32 s58, s49, 786432
    s_add_u32 s59, s49, 786560
    s_add_u32 s60, s49, 786688
    s_lshl_b32 s54, s32, 11
    s_lshl_b32 s40, s30, 1
    s_add_u32 s40, s40, s51
    s_lshl_b32 s40, s40, 5
    s_add_u32 s40, s40, s34
    s_lshl_b32 s40, s40, 1
    s_add_u32 s40, s40, s50
    s_lshl_b32 s40, s40, 4
    s_add_u32 s53, s40, 1048576
    s_lshl_b32 s40, s50, 10
    v_add_u32 v28, s40, v5
    v_xor_b32 v29, 32, v28
    v_xor_b32 v30, 64, v28
    v_xor_b32 v31, 96, v28
    s_lshl_b32 s41, s50, 6
    v_xor_b32 v5, s41, v5
    v_add_u32 v32, 2048, v5
    v_xor_b32 v33, 32, v32
    v_add_u32 v34, 81920, v28
    v_add_u32 v35, 81920, v29
    v_add_u32 v36, 81920, v30
    v_add_u32 v37, 81920, v31
    v_add_u32 v38, 81920, v32
    v_add_u32 v39, 81920, v33
    v_and_b32 v21, 15, v0
    v_lshrrev_b32 v5, 1, v21
    v_xor_b32 v5, v5, v4
    v_lshlrev_b32 v5, 4, v5
    v_lshl_add_u32 v5, v21, 7, v5
    s_lshl_b32 s42, s32, 11
    s_add_u32 s42, s42, 24576
    v_add_u32 v42, s42, v5
    v_xor_b32 v40, 2048, v42
    v_xor_b32 v41, 64, v40
    v_xor_b32 v43, 64, v42
    v_add_u32 v44, 81920, v40
    v_add_u32 v45, 81920, v41
    v_add_u32 v46, 81920, v42
    v_add_u32 v47, 81920, v43
    v_and_b32 v21, 15, v0
    v_lshrrev_b32 v5, 1, v21
    v_lshrrev_b32 v6, 5, v0
    v_xor_b32 v5, v5, v6
    v_lshlrev_b32 v5, 4, v5
    v_lshl_add_u32 v5, v21, 7, v5
    v_and_b32 v6, 1, v4
    v_lshl_add_u32 v5, v6, 3, v5
    s_lshl_b32 s42, s51, 12
    s_add_u32 s42, s42, 81920
    s_lshl_b32 s43, s50, 13
    s_add_u32 s43, s43, s42
    v_add_u32 v48, s43, v5
    v_xor_b32 v49, 32, v48
    v_xor_b32 v50, 64, v48
    v_xor_b32 v51, 96, v48
    v_xor_b32 v5, s41, v5
    s_add_u32 s42, s42, 16384
    v_add_u32 v52, s42, v5
    v_xor_b32 v53, 32, v52
    s_add_u32 s42, s54, 106496
    v_add_u32 v54, s42, v20
    v_xor_b32 v55, 2048, v54
    s_movk_i32 s43, 384
    v_mul_lo_u32 v5, v2, s43
    v_xor_b32 v6, v3, v4
    v_lshl_add_u32 v26, v6, 4, v5
    v_xor_b32 v27, 64, v26
    s_lshl_b32 s42, s43, 3
    s_sub_u32 s42, s42, 1024
    v_add_u32 v27, s42, v27
    s_bfe_u32 s40, s36, 0x40004
    s_add_u32 s40, s40, s28
    s_cmp_ge_u32 s40, 10
    s_cselect_b32 s41, 10, 0
    s_sub_u32 s40, s40, s41
    s_mul_i32 s66, s40, 786432
    s_add_u32 s66, s66, s44
    s_lshl_b32 s40, s40, 7
    s_add_u32 s67, s40, s45
    s_bfe_u32 s40, s36, 0x40008
    s_add_u32 s40, s40, s28
    s_cmp_ge_u32 s40, 10
    s_cselect_b32 s41, 10, 0
    s_sub_u32 s40, s40, s41
    s_mul_i32 s68, s40, 786432
    s_add_u32 s68, s68, s44
    s_lshl_b32 s40, s40, 7
    s_add_u32 s69, s40, s45
    s_bfe_u32 s40, s36, 0x4000c
    s_add_u32 s40, s40, s28
    s_cmp_ge_u32 s40, 10
    s_cselect_b32 s41, 10, 0
    s_sub_u32 s40, s40, s41
    s_mul_i32 s70, s40, 786432
    s_add_u32 s70, s70, s44
    s_lshl_b32 s40, s40, 7
    s_add_u32 s71, s40, s45
    s_bfe_u32 s40, s36, 0x40010
    s_add_u32 s40, s40, s28
    s_cmp_ge_u32 s40, 10
    s_cselect_b32 s41, 10, 0
    s_sub_u32 s40, s40, s41
    s_mul_i32 s72, s40, 786432
    s_add_u32 s72, s72, s44
    s_lshl_b32 s40, s40, 7
    s_add_u32 s73, s40, s45
    s_bfe_u32 s40, s36, 0x40014
    s_add_u32 s40, s40, s28
    s_cmp_ge_u32 s40, 10
    s_cselect_b32 s41, 10, 0
    s_sub_u32 s40, s40, s41
    s_mul_i32 s74, s40, 786432
    s_add_u32 s74, s74, s44
    s_lshl_b32 s40, s40, 7
    s_add_u32 s75, s40, s45
    s_bfe_u32 s40, s36, 0x40018
    s_add_u32 s40, s40, s28
    s_cmp_ge_u32 s40, 10
    s_cselect_b32 s41, 10, 0
    s_sub_u32 s40, s40, s41
    s_mul_i32 s76, s40, 786432
    s_add_u32 s76, s76, s44
    s_lshl_b32 s40, s40, 7
    s_add_u32 s77, s40, s45
    s_bfe_u32 s40, s36, 0x4001c
    s_add_u32 s40, s40, s28
    s_cmp_ge_u32 s40, 10
    s_cselect_b32 s41, 10, 0
    s_sub_u32 s40, s40, s41
    s_mul_i32 s78, s40, 786432
    s_add_u32 s78, s78, s44
    s_lshl_b32 s40, s40, 7
    s_add_u32 s79, s40, s45
    s_bfe_u32 s40, s37, 0x40000
    s_add_u32 s40, s40, s28
    s_cmp_ge_u32 s40, 10
    s_cselect_b32 s41, 10, 0
    s_sub_u32 s40, s40, s41
    s_mul_i32 s80, s40, 786432
    s_add_u32 s80, s80, s44
    s_lshl_b32 s40, s40, 7
    s_add_u32 s81, s40, s45
    s_bfe_u32 s40, s37, 0x40004
    s_add_u32 s40, s40, s28
    s_cmp_ge_u32 s40, 10
    s_cselect_b32 s41, 10, 0
    s_sub_u32 s40, s40, s41
    s_mul_i32 s82, s40, 786432
    s_add_u32 s82, s82, s44
    s_lshl_b32 s40, s40, 7
    s_add_u32 s83, s40, s45
    s_mov_b64 exec, 0
    s_cmp_eq_u32 s32, 0
    s_cbranch_scc1 A_PG0
    s_cmp_eq_u32 s32, 1
    s_cbranch_scc1 A_PG1
    s_cmp_eq_u32 s32, 2
    s_cbranch_scc1 A_PG2
    s_cmp_eq_u32 s32, 3
    s_cbranch_scc1 A_PG3
A_PG3:
A_PG2:
A_WARM_END:
    s_mov_b64 exec, -1
    s_branch A_MAIN
ROLE_B:
    s_mov_b32 s36, 0x563412b0
    s_mov_b32 s37, 0x9a78
    s_cmp_eq_u32 s31, 1
    s_cselect_b32 s36, 0x563412b0, s36
    s_cselect_b32 s37, 0x9a78, s37
    s_cmp_eq_u32 s31, 2
    s_cselect_b32 s36, 0x7452301a, s36
    s_cselect_b32 s37, 0xb896, s37
    s_cmp_eq_u32 s31, 3
    s_cselect_b32 s36, 0x7452301a, s36
    s_cselect_b32 s37, 0xb896, s37
    s_and_b32 s49, s29, 1
    s_mul_i32 s44, s34, 245760
    s_mul_i32 s40, s29, 320
    s_add_u32 s44, s44, s40
    s_lshl_b32 s40, s49, 6
    s_add_u32 s44, s44, s40
    s_mul_i32 s40, s34, 12288
    s_add_u32 s45, s45, s40
    s_lshl_b32 s40, s43, 1
    s_xor_b32 s40, s40, s32
    s_mul_i32 s3, s40, 6144
    s_lshl_b32 s40, s40, 4
    v_lshrrev_b32 v5, 2, v0
    v_add_u32 v5, s40, v5
    v_mul_u32_u24 v5, 1280, v5
    v_and_b32 v6, 2, v4
    v_and_b32 v21, 3, v0
    v_xor_b32 v6, v6, v21
    v_lshl_add_u32 v5, v6, 4, v5
    s_mul_i32 s40, s49, 320
    s_sub_u32 s40, 4352, s40
    v_add_u32 v10, s40, v5
    s_bfe_u32 s40, s36, 0x40000
    s_and_b32 s41, s40, 3
    s_lshr_b32 s40, s40, 2
    s_mul_i32 s42, s41, 3
    s_add_u32 s42, s42, s40
    s_mul_i32 s42, s42, 81920
    s_add_u32 s64, s42, s44
    s_mul_i32 s42, s41, 96
    s_add_u32 s42, s42, s40
    s_lshl_b32 s42, s42, 7
    s_add_u32 s65, s42, s45
    s_waitcnt lgkmcnt(0)
    s_sub_u32 s8, s8, 4096
    s_subb_u32 s9, s9, 0
    s_add_u32 m0, s38, 0
    s_nop 0
    buffer_load_dwordx4 v8, s[8:11], s64 offen lds
    buffer_load_dwordx4 v9, s[8:11], s64 offen offset:1024 lds
    s_add_u32 m0, s39, 0
    s_nop 0
    buffer_load_dwordx4 v14, s[4:7], s65 offen lds
    buffer_load_dwordx4 v15, s[4:7], s65 offen offset:1024 lds
    s_add_u32 m0, s3, 2048
    s_nop 0
    buffer_load_dwordx4 v10, s[8:11], s64 offen lds
    s_add_u32 m0, s47, 0
    s_nop 0
    buffer_load_dwordx4 v11, s[8:11], s64 offen lds
    buffer_load_dwordx4 v12, s[8:11], s64 offen offset:1024 lds
    s_add_u32 m0, s48, 0
    s_nop 0
    buffer_load_dwordx4 v16, s[4:7], s65 offen lds
    buffer_load_dwordx4 v17, s[4:7], s65 offen offset:1024 lds
    s_add_u32 m0, s38, 40960
    s_branch B_MAIN
.p2align 12
A_MAIN:
    buffer_load_dwordx4 v8, s[8:11], s66 offen lds
    buffer_load_dwordx4 v9, s[8:11], s66 offen offset:1024 lds
    buffer_load_dwordx4 v10, s[8:11], s66 offen offset:2048 lds
    s_add_u32 m0, s39, 40960
    s_nop 0
    buffer_load_dwordx4 v14, s[4:7], s67 offen lds
    buffer_load_dwordx4 v15, s[4:7], s67 offen offset:1024 lds
    s_add_u32 m0, s47, 40960
    s_nop 0
    buffer_load_dwordx4 v11, s[8:11], s66 offen lds
    buffer_load_dwordx4 v12, s[8:11], s66 offen offset:1024 lds
    buffer_load_dwordx4 v13, s[8:11], s66 offen offset:2048 lds
    s_add_u32 m0, s48, 40960
    s_nop 0
    buffer_load_dwordx4 v16, s[4:7], s67 offen lds
    buffer_load_dwordx4 v17, s[4:7], s67 offen offset:1024 lds
    s_add_u32 m0, s38, 81920
    s_waitcnt vmcnt(10)
    s_barrier
    ds_read_b64_tr_b16 a[0:1], v28 offset:0
    ds_read_b64_tr_b16 a[2:3], v28 offset:512
    ds_read_b128 a[96:99], v40 offset:0
    ds_read_b64_tr_b16 a[4:5], v28 offset:12288
    ds_read_b64_tr_b16 a[6:7], v28 offset:12800
    ds_read_b128 a[100:103], v41 offset:0
    ds_read_b128 a[104:107], v42 offset:0
    ds_read_b128 a[108:111], v43 offset:0
    ds_read_b128 a[112:115], v40 offset:8192
    ds_read_b128 a[116:119], v41 offset:8192
    ds_read_b128 a[120:123], v42 offset:8192
    ds_read_b128 a[124:127], v43 offset:8192
    s_waitcnt lgkmcnt(9)
    v_mfma_f32_16x16x32_bf16 v[64:67], a[0:3], a[96:99], 0
    ds_read_b64_tr_b16 a[8:9], v29 offset:0
    s_waitcnt lgkmcnt(7)
    v_mfma_f32_16x16x32_bf16 v[64:67], a[4:7], a[100:103], v[64:67]
    ds_read_b64_tr_b16 a[10:11], v29 offset:512
    s_waitcnt lgkmcnt(6)
    v_mfma_f32_16x16x32_bf16 v[68:71], a[4:7], a[108:111], 0
    ds_read_b64_tr_b16 a[12:13], v29 offset:12288
    v_mfma_f32_16x16x32_bf16 v[68:71], a[0:3], a[104:107], v[68:71]
    buffer_load_dwordx4 v8, s[8:11], s68 offen lds
    s_waitcnt lgkmcnt(6)
    v_mfma_f32_16x16x32_bf16 v[72:75], a[0:3], a[112:115], 0
    ds_read_b64_tr_b16 a[14:15], v29 offset:12800
    s_waitcnt lgkmcnt(3)
    v_mfma_f32_16x16x32_bf16 v[72:75], a[4:7], a[116:119], v[72:75]
    ds_read_b64_tr_b16 a[16:17], v30 offset:0
    v_mfma_f32_16x16x32_bf16 v[76:79], a[4:7], a[124:127], 0
    ds_read_b64_tr_b16 a[18:19], v30 offset:512
    v_mfma_f32_16x16x32_bf16 v[76:79], a[0:3], a[120:123], v[76:79]
    buffer_load_dwordx4 v9, s[8:11], s68 offen offset:1024 lds
    s_waitcnt lgkmcnt(3)
    v_mfma_f32_16x16x32_bf16 v[92:95], a[8:11], a[120:123], 0
    ds_read_b64_tr_b16 a[20:21], v30 offset:12288
    s_waitcnt lgkmcnt(3)
    v_mfma_f32_16x16x32_bf16 v[92:95], a[12:15], a[124:127], v[92:95]
    ds_read_b64_tr_b16 a[22:23], v30 offset:12800
    v_mfma_f32_16x16x32_bf16 v[88:91], a[12:15], a[116:119], 0
    ds_read_b64_tr_b16 a[24:25], v31 offset:0
    v_mfma_f32_16x16x32_bf16 v[88:91], a[8:11], a[112:115], v[88:91]
    buffer_load_dwordx4 v10, s[8:11], s68 offen offset:2048 lds
    s_add_u32 m0, s39, 81920
    v_mfma_f32_16x16x32_bf16 v[84:87], a[8:11], a[104:107], 0
    ds_read_b64_tr_b16 a[26:27], v31 offset:512
    v_mfma_f32_16x16x32_bf16 v[84:87], a[12:15], a[108:111], v[84:87]
    ds_read_b64_tr_b16 a[28:29], v31 offset:12288
    v_mfma_f32_16x16x32_bf16 v[80:83], a[12:15], a[100:103], 0
    ds_read_b64_tr_b16 a[30:31], v31 offset:12800
    v_mfma_f32_16x16x32_bf16 v[80:83], a[8:11], a[96:99], v[80:83]
    buffer_load_dwordx4 v14, s[4:7], s69 offen lds
    s_waitcnt lgkmcnt(3)
    v_mfma_f32_16x16x32_bf16 v[96:99], a[16:19], a[96:99], 0
    ds_read_b64_tr_b16 a[32:33], v32 offset:0
    v_mfma_f32_16x16x32_bf16 v[96:99], a[20:23], a[100:103], v[96:99]
    ds_read_b64_tr_b16 a[34:35], v32 offset:512
    v_mfma_f32_16x16x32_bf16 v[100:103], a[20:23], a[108:111], 0
    ds_read_b64_tr_b16 a[36:37], v32 offset:12288
    v_mfma_f32_16x16x32_bf16 v[100:103], a[16:19], a[104:107], v[100:103]
    buffer_load_dwordx4 v15, s[4:7], s69 offen offset:1024 lds
    s_add_u32 m0, s47, 81920
    v_mfma_f32_16x16x32_bf16 v[104:107], a[16:19], a[112:115], 0
    ds_read_b64_tr_b16 a[38:39], v32 offset:12800
    v_mfma_f32_16x16x32_bf16 v[104:107], a[20:23], a[116:119], v[104:107]
    ds_read_b64_tr_b16 a[40:41], v33 offset:0
    v_mfma_f32_16x16x32_bf16 v[108:111], a[20:23], a[124:127], 0
    ds_read_b64_tr_b16 a[42:43], v33 offset:512
    v_mfma_f32_16x16x32_bf16 v[108:111], a[16:19], a[120:123], v[108:111]
    buffer_load_dwordx4 v11, s[8:11], s68 offen lds
    s_waitcnt lgkmcnt(3)
    v_mfma_f32_16x16x32_bf16 v[124:127], a[24:27], a[120:123], 0
    ds_read_b64_tr_b16 a[44:45], v33 offset:12288
    v_mfma_f32_16x16x32_bf16 v[124:127], a[28:31], a[124:127], v[124:127]
    ds_read_b64_tr_b16 a[46:47], v33 offset:12800
    v_mfma_f32_16x16x32_bf16 v[120:123], a[28:31], a[116:119], 0
    buffer_load_dwordx4 v12, s[8:11], s68 offen offset:1024 lds
    v_mfma_f32_16x16x32_bf16 v[120:123], a[24:27], a[112:115], v[120:123]
    v_mfma_f32_16x16x32_bf16 v[116:119], a[24:27], a[104:107], 0
    v_mfma_f32_16x16x32_bf16 v[116:119], a[28:31], a[108:111], v[116:119]
    s_waitcnt vmcnt(7) lgkmcnt(0)
    s_barrier
    v_mfma_f32_16x16x32_bf16 v[112:115], a[28:31], a[100:103], 0
    ds_read_b64_tr_b16 a[0:1], v28 offset:40960
    v_mfma_f32_16x16x32_bf16 v[112:115], a[24:27], a[96:99], v[112:115]
    ds_read_b64_tr_b16 a[2:3], v28 offset:41472
    v_mfma_f32_16x16x32_bf16 v[128:131], a[32:35], a[96:99], 0
    ds_read_b128 a[128:131], v40 offset:40960
    v_mfma_f32_16x16x32_bf16 v[128:131], a[36:39], a[100:103], v[128:131]
    buffer_load_dwordx4 v13, s[8:11], s68 offen offset:2048 lds
    s_add_u32 m0, s48, 81920
    v_mfma_f32_16x16x32_bf16 v[132:135], a[36:39], a[108:111], 0
    ds_read_b64_tr_b16 a[4:5], v28 offset:53248
    v_mfma_f32_16x16x32_bf16 v[132:135], a[32:35], a[104:107], v[132:135]
    ds_read_b64_tr_b16 a[6:7], v28 offset:53760
    v_mfma_f32_16x16x32_bf16 v[136:139], a[32:35], a[112:115], 0
    ds_read_b128 a[132:135], v41 offset:40960
    v_mfma_f32_16x16x32_bf16 v[136:139], a[36:39], a[116:119], v[136:139]
    buffer_load_dwordx4 v16, s[4:7], s69 offen lds
    v_mfma_f32_16x16x32_bf16 v[140:143], a[36:39], a[124:127], 0
    ds_read_b128 a[136:139], v42 offset:40960
    v_mfma_f32_16x16x32_bf16 v[140:143], a[32:35], a[120:123], v[140:143]
    ds_read_b128 a[140:143], v43 offset:40960
    v_mfma_f32_16x16x32_bf16 v[156:159], a[40:43], a[120:123], 0
    ds_read_b128 a[144:147], v40 offset:49152
    v_mfma_f32_16x16x32_bf16 v[156:159], a[44:47], a[124:127], v[156:159]
    buffer_load_dwordx4 v17, s[4:7], s69 offen offset:1024 lds
    s_add_u32 m0, s38, 122880
    v_mfma_f32_16x16x32_bf16 v[152:155], a[44:47], a[116:119], 0
    ds_read_b128 a[148:151], v41 offset:49152
    v_mfma_f32_16x16x32_bf16 v[152:155], a[40:43], a[112:115], v[152:155]
    ds_read_b128 a[152:155], v42 offset:49152
    v_mfma_f32_16x16x32_bf16 v[148:151], a[40:43], a[104:107], 0
    ds_read_b128 a[156:159], v43 offset:49152
    v_mfma_f32_16x16x32_bf16 v[148:151], a[44:47], a[108:111], v[148:151]
    buffer_load_dwordx4 v8, s[8:11], s70 offen lds
    v_mfma_f32_16x16x32_bf16 v[144:147], a[44:47], a[100:103], 0
    buffer_load_dwordx4 v9, s[8:11], s70 offen offset:1024 lds
    v_mfma_f32_16x16x32_bf16 v[144:147], a[40:43], a[96:99], v[144:147]
    s_waitcnt lgkmcnt(1)
    v_mfma_f32_16x16x32_bf16 v[64:67], a[0:3], a[128:131], v[64:67]
    ds_read_b64_tr_b16 a[8:9], v29 offset:40960
    v_mfma_f32_16x16x32_bf16 v[64:67], a[4:7], a[132:135], v[64:67]
    ds_read_b64_tr_b16 a[10:11], v29 offset:41472
    v_mfma_f32_16x16x32_bf16 v[68:71], a[4:7], a[140:143], v[68:71]
    ds_read_b64_tr_b16 a[12:13], v29 offset:53248
    v_mfma_f32_16x16x32_bf16 v[68:71], a[0:3], a[136:139], v[68:71]
    buffer_load_dwordx4 v10, s[8:11], s70 offen offset:2048 lds
    s_add_u32 m0, s39, 122880
    v_mfma_f32_16x16x32_bf16 v[72:75], a[0:3], a[144:147], v[72:75]
    ds_read_b64_tr_b16 a[14:15], v29 offset:53760
    v_mfma_f32_16x16x32_bf16 v[72:75], a[4:7], a[148:151], v[72:75]
    ds_read_b64_tr_b16 a[16:17], v30 offset:40960
    s_waitcnt lgkmcnt(3)
    v_mfma_f32_16x16x32_bf16 v[76:79], a[4:7], a[156:159], v[76:79]
    ds_read_b64_tr_b16 a[18:19], v30 offset:41472
    v_mfma_f32_16x16x32_bf16 v[76:79], a[0:3], a[152:155], v[76:79]
    buffer_load_dwordx4 v14, s[4:7], s71 offen lds
    v_mfma_f32_16x16x32_bf16 v[92:95], a[8:11], a[152:155], v[92:95]
    ds_read_b64_tr_b16 a[20:21], v30 offset:53248
    s_waitcnt lgkmcnt(3)
    v_mfma_f32_16x16x32_bf16 v[92:95], a[12:15], a[156:159], v[92:95]
    ds_read_b64_tr_b16 a[22:23], v30 offset:53760
    v_mfma_f32_16x16x32_bf16 v[88:91], a[12:15], a[148:151], v[88:91]
    ds_read_b64_tr_b16 a[24:25], v31 offset:40960
    v_mfma_f32_16x16x32_bf16 v[88:91], a[8:11], a[144:147], v[88:91]
    buffer_load_dwordx4 v15, s[4:7], s71 offen offset:1024 lds
    s_add_u32 m0, s47, 122880
    v_mfma_f32_16x16x32_bf16 v[84:87], a[8:11], a[136:139], v[84:87]
    ds_read_b64_tr_b16 a[26:27], v31 offset:41472
    v_mfma_f32_16x16x32_bf16 v[84:87], a[12:15], a[140:143], v[84:87]
    ds_read_b64_tr_b16 a[28:29], v31 offset:53248
    v_mfma_f32_16x16x32_bf16 v[80:83], a[12:15], a[132:135], v[80:83]
    ds_read_b64_tr_b16 a[30:31], v31 offset:53760
    v_mfma_f32_16x16x32_bf16 v[80:83], a[8:11], a[128:131], v[80:83]
    buffer_load_dwordx4 v11, s[8:11], s70 offen lds
    s_waitcnt lgkmcnt(3)
    v_mfma_f32_16x16x32_bf16 v[96:99], a[16:19], a[128:131], v[96:99]
    ds_read_b64_tr_b16 a[32:33], v32 offset:40960
    v_mfma_f32_16x16x32_bf16 v[96:99], a[20:23], a[132:135], v[96:99]
    ds_read_b64_tr_b16 a[34:35], v32 offset:41472
    v_mfma_f32_16x16x32_bf16 v[100:103], a[20:23], a[140:143], v[100:103]
    ds_read_b64_tr_b16 a[36:37], v32 offset:53248
    v_mfma_f32_16x16x32_bf16 v[100:103], a[16:19], a[136:139], v[100:103]
    buffer_load_dwordx4 v12, s[8:11], s70 offen offset:1024 lds
    v_mfma_f32_16x16x32_bf16 v[104:107], a[16:19], a[144:147], v[104:107]
    ds_read_b64_tr_b16 a[38:39], v32 offset:53760
    v_mfma_f32_16x16x32_bf16 v[104:107], a[20:23], a[148:151], v[104:107]
    ds_read_b64_tr_b16 a[40:41], v33 offset:40960
    v_mfma_f32_16x16x32_bf16 v[108:111], a[20:23], a[156:159], v[108:111]
    ds_read_b64_tr_b16 a[42:43], v33 offset:41472
    v_mfma_f32_16x16x32_bf16 v[108:111], a[16:19], a[152:155], v[108:111]
    buffer_load_dwordx4 v13, s[8:11], s70 offen offset:2048 lds
    s_add_u32 m0, s48, 122880
    s_waitcnt lgkmcnt(3)
    v_mfma_f32_16x16x32_bf16 v[124:127], a[24:27], a[152:155], v[124:127]
    ds_read_b64_tr_b16 a[44:45], v33 offset:53248
    v_mfma_f32_16x16x32_bf16 v[124:127], a[28:31], a[156:159], v[124:127]
    ds_read_b64_tr_b16 a[46:47], v33 offset:53760
    v_mfma_f32_16x16x32_bf16 v[120:123], a[28:31], a[148:151], v[120:123]
    buffer_load_dwordx4 v16, s[4:7], s71 offen lds
    v_mfma_f32_16x16x32_bf16 v[120:123], a[24:27], a[144:147], v[120:123]
    v_mfma_f32_16x16x32_bf16 v[116:119], a[24:27], a[136:139], v[116:119]
    v_mfma_f32_16x16x32_bf16 v[116:119], a[28:31], a[140:143], v[116:119]
    s_waitcnt vmcnt(9) lgkmcnt(0)
    s_barrier
    v_mfma_f32_16x16x32_bf16 v[112:115], a[28:31], a[132:135], v[112:115]
    ds_read_b64_tr_b16 a[0:1], v34 offset:0
    v_mfma_f32_16x16x32_bf16 v[112:115], a[24:27], a[128:131], v[112:115]
    ds_read_b64_tr_b16 a[2:3], v34 offset:512
    v_mfma_f32_16x16x32_bf16 v[128:131], a[32:35], a[128:131], v[128:131]
    ds_read_b128 a[96:99], v44 offset:0
    v_mfma_f32_16x16x32_bf16 v[128:131], a[36:39], a[132:135], v[128:131]
    buffer_load_dwordx4 v17, s[4:7], s71 offen offset:1024 lds
    s_add_u32 m0, s38, 0
    v_mfma_f32_16x16x32_bf16 v[132:135], a[36:39], a[140:143], v[132:135]
    ds_read_b64_tr_b16 a[4:5], v34 offset:12288
    v_mfma_f32_16x16x32_bf16 v[132:135], a[32:35], a[136:139], v[132:135]
    ds_read_b64_tr_b16 a[6:7], v34 offset:12800
    v_mfma_f32_16x16x32_bf16 v[136:139], a[32:35], a[144:147], v[136:139]
    ds_read_b128 a[100:103], v45 offset:0
    v_mfma_f32_16x16x32_bf16 v[136:139], a[36:39], a[148:151], v[136:139]
    buffer_load_dwordx4 v8, s[8:11], s72 offen lds
    v_mfma_f32_16x16x32_bf16 v[140:143], a[36:39], a[156:159], v[140:143]
    ds_read_b128 a[104:107], v46 offset:0
    v_mfma_f32_16x16x32_bf16 v[140:143], a[32:35], a[152:155], v[140:143]
    ds_read_b128 a[108:111], v47 offset:0
    v_mfma_f32_16x16x32_bf16 v[156:159], a[40:43], a[152:155], v[156:159]
    ds_read_b128 a[112:115], v44 offset:8192
    v_mfma_f32_16x16x32_bf16 v[156:159], a[44:47], a[156:159], v[156:159]
    buffer_load_dwordx4 v9, s[8:11], s72 offen offset:1024 lds
    v_mfma_f32_16x16x32_bf16 v[152:155], a[44:47], a[148:151], v[152:155]
    ds_read_b128 a[116:119], v45 offset:8192
    v_mfma_f32_16x16x32_bf16 v[152:155], a[40:43], a[144:147], v[152:155]
    ds_read_b128 a[120:123], v46 offset:8192
    v_mfma_f32_16x16x32_bf16 v[148:151], a[40:43], a[136:139], v[148:151]
    ds_read_b128 a[124:127], v47 offset:8192
    v_mfma_f32_16x16x32_bf16 v[148:151], a[44:47], a[140:143], v[148:151]
    buffer_load_dwordx4 v10, s[8:11], s72 offen offset:2048 lds
    s_add_u32 m0, s39, 0
    v_mfma_f32_16x16x32_bf16 v[144:147], a[44:47], a[132:135], v[144:147]
    buffer_load_dwordx4 v14, s[4:7], s73 offen lds
    v_mfma_f32_16x16x32_bf16 v[144:147], a[40:43], a[128:131], v[144:147]
    s_waitcnt lgkmcnt(1)
    v_mfma_f32_16x16x32_bf16 v[64:67], a[0:3], a[96:99], v[64:67]
    ds_read_b64_tr_b16 a[8:9], v35 offset:0
    v_mfma_f32_16x16x32_bf16 v[64:67], a[4:7], a[100:103], v[64:67]
    ds_read_b64_tr_b16 a[10:11], v35 offset:512
    v_mfma_f32_16x16x32_bf16 v[68:71], a[4:7], a[108:111], v[68:71]
    ds_read_b64_tr_b16 a[12:13], v35 offset:12288
    v_mfma_f32_16x16x32_bf16 v[68:71], a[0:3], a[104:107], v[68:71]
    buffer_load_dwordx4 v15, s[4:7], s73 offen offset:1024 lds
    s_add_u32 m0, s47, 0
    v_mfma_f32_16x16x32_bf16 v[72:75], a[0:3], a[112:115], v[72:75]
    ds_read_b64_tr_b16 a[14:15], v35 offset:12800
    v_mfma_f32_16x16x32_bf16 v[72:75], a[4:7], a[116:119], v[72:75]
    ds_read_b64_tr_b16 a[16:17], v36 offset:0
    s_waitcnt lgkmcnt(3)
    v_mfma_f32_16x16x32_bf16 v[76:79], a[4:7], a[124:127], v[76:79]
    ds_read_b64_tr_b16 a[18:19], v36 offset:512
    v_mfma_f32_16x16x32_bf16 v[76:79], a[0:3], a[120:123], v[76:79]
    buffer_load_dwordx4 v11, s[8:11], s72 offen lds
    v_mfma_f32_16x16x32_bf16 v[92:95], a[8:11], a[120:123], v[92:95]
    ds_read_b64_tr_b16 a[20:21], v36 offset:12288
    s_waitcnt lgkmcnt(3)
    v_mfma_f32_16x16x32_bf16 v[92:95], a[12:15], a[124:127], v[92:95]
    ds_read_b64_tr_b16 a[22:23], v36 offset:12800
    v_mfma_f32_16x16x32_bf16 v[88:91], a[12:15], a[116:119], v[88:91]
    ds_read_b64_tr_b16 a[24:25], v37 offset:0
    v_mfma_f32_16x16x32_bf16 v[88:91], a[8:11], a[112:115], v[88:91]
    buffer_load_dwordx4 v12, s[8:11], s72 offen offset:1024 lds
    v_mfma_f32_16x16x32_bf16 v[84:87], a[8:11], a[104:107], v[84:87]
    ds_read_b64_tr_b16 a[26:27], v37 offset:512
    v_mfma_f32_16x16x32_bf16 v[84:87], a[12:15], a[108:111], v[84:87]
    ds_read_b64_tr_b16 a[28:29], v37 offset:12288
    v_mfma_f32_16x16x32_bf16 v[80:83], a[12:15], a[100:103], v[80:83]
    ds_read_b64_tr_b16 a[30:31], v37 offset:12800
    v_mfma_f32_16x16x32_bf16 v[80:83], a[8:11], a[96:99], v[80:83]
    buffer_load_dwordx4 v13, s[8:11], s72 offen offset:2048 lds
    s_add_u32 m0, s48, 0
    s_waitcnt lgkmcnt(3)
    v_mfma_f32_16x16x32_bf16 v[96:99], a[16:19], a[96:99], v[96:99]
    ds_read_b64_tr_b16 a[32:33], v38 offset:0
    v_mfma_f32_16x16x32_bf16 v[96:99], a[20:23], a[100:103], v[96:99]
    ds_read_b64_tr_b16 a[34:35], v38 offset:512
    v_mfma_f32_16x16x32_bf16 v[100:103], a[20:23], a[108:111], v[100:103]
    ds_read_b64_tr_b16 a[36:37], v38 offset:12288
    v_mfma_f32_16x16x32_bf16 v[100:103], a[16:19], a[104:107], v[100:103]
    buffer_load_dwordx4 v16, s[4:7], s73 offen lds
    v_mfma_f32_16x16x32_bf16 v[104:107], a[16:19], a[112:115], v[104:107]
    ds_read_b64_tr_b16 a[38:39], v38 offset:12800
    v_mfma_f32_16x16x32_bf16 v[104:107], a[20:23], a[116:119], v[104:107]
    ds_read_b64_tr_b16 a[40:41], v39 offset:0
    v_mfma_f32_16x16x32_bf16 v[108:111], a[20:23], a[124:127], v[108:111]
    ds_read_b64_tr_b16 a[42:43], v39 offset:512
    v_mfma_f32_16x16x32_bf16 v[108:111], a[16:19], a[120:123], v[108:111]
    buffer_load_dwordx4 v17, s[4:7], s73 offen offset:1024 lds
    s_add_u32 m0, s38, 40960
    s_waitcnt lgkmcnt(3)
    v_mfma_f32_16x16x32_bf16 v[124:127], a[24:27], a[120:123], v[124:127]
    ds_read_b64_tr_b16 a[44:45], v39 offset:12288
    v_mfma_f32_16x16x32_bf16 v[124:127], a[28:31], a[124:127], v[124:127]
    ds_read_b64_tr_b16 a[46:47], v39 offset:12800
    v_mfma_f32_16x16x32_bf16 v[120:123], a[28:31], a[116:119], v[120:123]
    buffer_load_dwordx4 v8, s[8:11], s74 offen lds
    v_mfma_f32_16x16x32_bf16 v[120:123], a[24:27], a[112:115], v[120:123]
    v_mfma_f32_16x16x32_bf16 v[116:119], a[24:27], a[104:107], v[116:119]
    v_mfma_f32_16x16x32_bf16 v[116:119], a[28:31], a[108:111], v[116:119]
    s_waitcnt vmcnt(11) lgkmcnt(0)
    s_barrier
    v_mfma_f32_16x16x32_bf16 v[112:115], a[28:31], a[100:103], v[112:115]
    ds_read_b64_tr_b16 a[0:1], v34 offset:40960
    v_mfma_f32_16x16x32_bf16 v[112:115], a[24:27], a[96:99], v[112:115]
    ds_read_b64_tr_b16 a[2:3], v34 offset:41472
    v_mfma_f32_16x16x32_bf16 v[128:131], a[32:35], a[96:99], v[128:131]
    ds_read_b128 a[128:131], v44 offset:40960
    v_mfma_f32_16x16x32_bf16 v[128:131], a[36:39], a[100:103], v[128:131]
    buffer_load_dwordx4 v9, s[8:11], s74 offen offset:1024 lds
    v_mfma_f32_16x16x32_bf16 v[132:135], a[36:39], a[108:111], v[132:135]
    ds_read_b64_tr_b16 a[4:5], v34 offset:53248
    v_mfma_f32_16x16x32_bf16 v[132:135], a[32:35], a[104:107], v[132:135]
    ds_read_b64_tr_b16 a[6:7], v34 offset:53760
    v_mfma_f32_16x16x32_bf16 v[136:139], a[32:35], a[112:115], v[136:139]
    ds_read_b128 a[132:135], v45 offset:40960
    v_mfma_f32_16x16x32_bf16 v[136:139], a[36:39], a[116:119], v[136:139]
    buffer_load_dwordx4 v10, s[8:11], s74 offen offset:2048 lds
    s_add_u32 m0, s39, 40960
    v_mfma_f32_16x16x32_bf16 v[140:143], a[36:39], a[124:127], v[140:143]
    ds_read_b128 a[136:139], v46 offset:40960
    v_mfma_f32_16x16x32_bf16 v[140:143], a[32:35], a[120:123], v[140:143]
    ds_read_b128 a[140:143], v47 offset:40960
    v_mfma_f32_16x16x32_bf16 v[156:159], a[40:43], a[120:123], v[156:159]
    ds_read_b128 a[144:147], v44 offset:49152
    v_mfma_f32_16x16x32_bf16 v[156:159], a[44:47], a[124:127], v[156:159]
    buffer_load_dwordx4 v14, s[4:7], s75 offen lds
    v_mfma_f32_16x16x32_bf16 v[152:155], a[44:47], a[116:119], v[152:155]
    ds_read_b128 a[148:151], v45 offset:49152
    v_mfma_f32_16x16x32_bf16 v[152:155], a[40:43], a[112:115], v[152:155]
    ds_read_b128 a[152:155], v46 offset:49152
    v_mfma_f32_16x16x32_bf16 v[148:151], a[40:43], a[104:107], v[148:151]
    ds_read_b128 a[156:159], v47 offset:49152
    v_mfma_f32_16x16x32_bf16 v[148:151], a[44:47], a[108:111], v[148:151]
    buffer_load_dwordx4 v15, s[4:7], s75 offen offset:1024 lds
    s_add_u32 m0, s47, 40960
    v_mfma_f32_16x16x32_bf16 v[144:147], a[44:47], a[100:103], v[144:147]
    buffer_load_dwordx4 v11, s[8:11], s74 offen lds
    v_mfma_f32_16x16x32_bf16 v[144:147], a[40:43], a[96:99], v[144:147]
    s_waitcnt lgkmcnt(1)
    v_mfma_f32_16x16x32_bf16 v[64:67], a[0:3], a[128:131], v[64:67]
    ds_read_b64_tr_b16 a[8:9], v35 offset:40960
    v_mfma_f32_16x16x32_bf16 v[64:67], a[4:7], a[132:135], v[64:67]
    ds_read_b64_tr_b16 a[10:11], v35 offset:41472
    v_mfma_f32_16x16x32_bf16 v[68:71], a[4:7], a[140:143], v[68:71]
    ds_read_b64_tr_b16 a[12:13], v35 offset:53248
    v_mfma_f32_16x16x32_bf16 v[68:71], a[0:3], a[136:139], v[68:71]
    buffer_load_dwordx4 v12, s[8:11], s74 offen offset:1024 lds
    v_mfma_f32_16x16x32_bf16 v[72:75], a[0:3], a[144:147], v[72:75]
    ds_read_b64_tr_b16 a[14:15], v35 offset:53760
    v_mfma_f32_16x16x32_bf16 v[72:75], a[4:7], a[148:151], v[72:75]
    ds_read_b64_tr_b16 a[16:17], v36 offset:40960
    s_waitcnt lgkmcnt(3)
    v_mfma_f32_16x16x32_bf16 v[76:79], a[4:7], a[156:159], v[76:79]
    ds_read_b64_tr_b16 a[18:19], v36 offset:41472
    v_mfma_f32_16x16x32_bf16 v[76:79], a[0:3], a[152:155], v[76:79]
    buffer_load_dwordx4 v13, s[8:11], s74 offen offset:2048 lds
    s_add_u32 m0, s48, 40960
    v_mfma_f32_16x16x32_bf16 v[92:95], a[8:11], a[152:155], v[92:95]
    ds_read_b64_tr_b16 a[20:21], v36 offset:53248
    s_waitcnt lgkmcnt(3)
    v_mfma_f32_16x16x32_bf16 v[92:95], a[12:15], a[156:159], v[92:95]
    ds_read_b64_tr_b16 a[22:23], v36 offset:53760
    v_mfma_f32_16x16x32_bf16 v[88:91], a[12:15], a[148:151], v[88:91]
    ds_read_b64_tr_b16 a[24:25], v37 offset:40960
    v_mfma_f32_16x16x32_bf16 v[88:91], a[8:11], a[144:147], v[88:91]
    buffer_load_dwordx4 v16, s[4:7], s75 offen lds
    v_mfma_f32_16x16x32_bf16 v[84:87], a[8:11], a[136:139], v[84:87]
    ds_read_b64_tr_b16 a[26:27], v37 offset:41472
    v_mfma_f32_16x16x32_bf16 v[84:87], a[12:15], a[140:143], v[84:87]
    ds_read_b64_tr_b16 a[28:29], v37 offset:53248
    v_mfma_f32_16x16x32_bf16 v[80:83], a[12:15], a[132:135], v[80:83]
    ds_read_b64_tr_b16 a[30:31], v37 offset:53760
    v_mfma_f32_16x16x32_bf16 v[80:83], a[8:11], a[128:131], v[80:83]
    buffer_load_dwordx4 v17, s[4:7], s75 offen offset:1024 lds
    s_add_u32 m0, s38, 81920
    s_waitcnt lgkmcnt(3)
    v_mfma_f32_16x16x32_bf16 v[96:99], a[16:19], a[128:131], v[96:99]
    ds_read_b64_tr_b16 a[32:33], v38 offset:40960
    v_mfma_f32_16x16x32_bf16 v[96:99], a[20:23], a[132:135], v[96:99]
    ds_read_b64_tr_b16 a[34:35], v38 offset:41472
    v_mfma_f32_16x16x32_bf16 v[100:103], a[20:23], a[140:143], v[100:103]
    ds_read_b64_tr_b16 a[36:37], v38 offset:53248
    v_mfma_f32_16x16x32_bf16 v[100:103], a[16:19], a[136:139], v[100:103]
    buffer_load_dwordx4 v8, s[8:11], s76 offen lds
    v_mfma_f32_16x16x32_bf16 v[104:107], a[16:19], a[144:147], v[104:107]
    ds_read_b64_tr_b16 a[38:39], v38 offset:53760
    v_mfma_f32_16x16x32_bf16 v[104:107], a[20:23], a[148:151], v[104:107]
    ds_read_b64_tr_b16 a[40:41], v39 offset:40960
    v_mfma_f32_16x16x32_bf16 v[108:111], a[20:23], a[156:159], v[108:111]
    ds_read_b64_tr_b16 a[42:43], v39 offset:41472
    v_mfma_f32_16x16x32_bf16 v[108:111], a[16:19], a[152:155], v[108:111]
    buffer_load_dwordx4 v9, s[8:11], s76 offen offset:1024 lds
    s_waitcnt lgkmcnt(3)
    v_mfma_f32_16x16x32_bf16 v[124:127], a[24:27], a[152:155], v[124:127]
    ds_read_b64_tr_b16 a[44:45], v39 offset:53248
    v_mfma_f32_16x16x32_bf16 v[124:127], a[28:31], a[156:159], v[124:127]
    ds_read_b64_tr_b16 a[46:47], v39 offset:53760
    v_mfma_f32_16x16x32_bf16 v[120:123], a[28:31], a[148:151], v[120:123]
    buffer_load_dwordx4 v10, s[8:11], s76 offen offset:2048 lds
    s_add_u32 m0, s39, 81920
    v_mfma_f32_16x16x32_bf16 v[120:123], a[24:27], a[144:147], v[120:123]
    v_mfma_f32_16x16x32_bf16 v[116:119], a[24:27], a[136:139], v[116:119]
    v_mfma_f32_16x16x32_bf16 v[116:119], a[28:31], a[140:143], v[116:119]
    s_waitcnt vmcnt(13) lgkmcnt(0)
    s_barrier
    v_mfma_f32_16x16x32_bf16 v[112:115], a[28:31], a[132:135], v[112:115]
    ds_read_b64_tr_b16 a[0:1], v28 offset:0
    v_mfma_f32_16x16x32_bf16 v[112:115], a[24:27], a[128:131], v[112:115]
    ds_read_b64_tr_b16 a[2:3], v28 offset:512
    v_mfma_f32_16x16x32_bf16 v[128:131], a[32:35], a[128:131], v[128:131]
    ds_read_b128 a[96:99], v40 offset:0
    v_mfma_f32_16x16x32_bf16 v[128:131], a[36:39], a[132:135], v[128:131]
    buffer_load_dwordx4 v14, s[4:7], s77 offen lds
    v_mfma_f32_16x16x32_bf16 v[132:135], a[36:39], a[140:143], v[132:135]
    ds_read_b64_tr_b16 a[4:5], v28 offset:12288
    v_mfma_f32_16x16x32_bf16 v[132:135], a[32:35], a[136:139], v[132:135]
    ds_read_b64_tr_b16 a[6:7], v28 offset:12800
    v_mfma_f32_16x16x32_bf16 v[136:139], a[32:35], a[144:147], v[136:139]
    ds_read_b128 a[100:103], v41 offset:0
    v_mfma_f32_16x16x32_bf16 v[136:139], a[36:39], a[148:151], v[136:139]
    buffer_load_dwordx4 v15, s[4:7], s77 offen offset:1024 lds
    s_add_u32 m0, s47, 81920
    v_mfma_f32_16x16x32_bf16 v[140:143], a[36:39], a[156:159], v[140:143]
    ds_read_b128 a[104:107], v42 offset:0
    v_mfma_f32_16x16x32_bf16 v[140:143], a[32:35], a[152:155], v[140:143]
    ds_read_b128 a[108:111], v43 offset:0
    v_mfma_f32_16x16x32_bf16 v[156:159], a[40:43], a[152:155], v[156:159]
    ds_read_b128 a[112:115], v40 offset:8192
    v_mfma_f32_16x16x32_bf16 v[156:159], a[44:47], a[156:159], v[156:159]
    buffer_load_dwordx4 v11, s[8:11], s76 offen lds
    v_mfma_f32_16x16x32_bf16 v[152:155], a[44:47], a[148:151], v[152:155]
    ds_read_b128 a[116:119], v41 offset:8192
    v_mfma_f32_16x16x32_bf16 v[152:155], a[40:43], a[144:147], v[152:155]
    ds_read_b128 a[120:123], v42 offset:8192
    v_mfma_f32_16x16x32_bf16 v[148:151], a[40:43], a[136:139], v[148:151]
    ds_read_b128 a[124:127], v43 offset:8192
    v_mfma_f32_16x16x32_bf16 v[148:151], a[44:47], a[140:143], v[148:151]
    buffer_load_dwordx4 v12, s[8:11], s76 offen offset:1024 lds
    v_mfma_f32_16x16x32_bf16 v[144:147], a[44:47], a[132:135], v[144:147]
    buffer_load_dwordx4 v13, s[8:11], s76 offen offset:2048 lds
    s_add_u32 m0, s48, 81920
    v_mfma_f32_16x16x32_bf16 v[144:147], a[40:43], a[128:131], v[144:147]
    s_waitcnt lgkmcnt(1)
    v_mfma_f32_16x16x32_bf16 v[64:67], a[0:3], a[96:99], v[64:67]
    ds_read_b64_tr_b16 a[8:9], v29 offset:0
    v_mfma_f32_16x16x32_bf16 v[64:67], a[4:7], a[100:103], v[64:67]
    ds_read_b64_tr_b16 a[10:11], v29 offset:512
    v_mfma_f32_16x16x32_bf16 v[68:71], a[4:7], a[108:111], v[68:71]
    ds_read_b64_tr_b16 a[12:13], v29 offset:12288
    v_mfma_f32_16x16x32_bf16 v[68:71], a[0:3], a[104:107], v[68:71]
    buffer_load_dwordx4 v16, s[4:7], s77 offen lds
    v_mfma_f32_16x16x32_bf16 v[72:75], a[0:3], a[112:115], v[72:75]
    ds_read_b64_tr_b16 a[14:15], v29 offset:12800
    v_mfma_f32_16x16x32_bf16 v[72:75], a[4:7], a[116:119], v[72:75]
    ds_read_b64_tr_b16 a[16:17], v30 offset:0
    s_waitcnt lgkmcnt(3)
    v_mfma_f32_16x16x32_bf16 v[76:79], a[4:7], a[124:127], v[76:79]
    ds_read_b64_tr_b16 a[18:19], v30 offset:512
    v_mfma_f32_16x16x32_bf16 v[76:79], a[0:3], a[120:123], v[76:79]
    buffer_load_dwordx4 v17, s[4:7], s77 offen offset:1024 lds
    v_mfma_f32_16x16x32_bf16 v[92:95], a[8:11], a[120:123], v[92:95]
    ds_read_b64_tr_b16 a[20:21], v30 offset:12288
    s_waitcnt lgkmcnt(3)
    v_mfma_f32_16x16x32_bf16 v[92:95], a[12:15], a[124:127], v[92:95]
    ds_read_b64_tr_b16 a[22:23], v30 offset:12800
    v_mfma_f32_16x16x32_bf16 v[88:91], a[12:15], a[116:119], v[88:91]
    ds_read_b64_tr_b16 a[24:25], v31 offset:0
    v_mfma_f32_16x16x32_bf16 v[88:91], a[8:11], a[112:115], v[88:91]
    buffer_store_dwordx4 v[160:163], v20, s[16:19], s52 offen sc1
    v_mfma_f32_16x16x32_bf16 v[84:87], a[8:11], a[104:107], v[84:87]
    ds_read_b64_tr_b16 a[26:27], v31 offset:512
    v_mfma_f32_16x16x32_bf16 v[84:87], a[12:15], a[108:111], v[84:87]
    ds_read_b64_tr_b16 a[28:29], v31 offset:12288
    v_mfma_f32_16x16x32_bf16 v[80:83], a[12:15], a[100:103], v[80:83]
    ds_read_b64_tr_b16 a[30:31], v31 offset:12800
    v_mfma_f32_16x16x32_bf16 v[80:83], a[8:11], a[96:99], v[80:83]
    buffer_store_dwordx4 v[160:163], v20, s[16:19], s61 offen sc1
    s_add_u32 m0, s38, 122880
    s_waitcnt lgkmcnt(3)
    v_mfma_f32_16x16x32_bf16 v[96:99], a[16:19], a[96:99], v[96:99]
    ds_read_b64_tr_b16 a[32:33], v32 offset:0
    v_mfma_f32_16x16x32_bf16 v[96:99], a[20:23], a[100:103], v[96:99]
    ds_read_b64_tr_b16 a[34:35], v32 offset:512
    v_mfma_f32_16x16x32_bf16 v[100:103], a[20:23], a[108:111], v[100:103]
    ds_read_b64_tr_b16 a[36:37], v32 offset:12288
    v_mfma_f32_16x16x32_bf16 v[100:103], a[16:19], a[104:107], v[100:103]
    buffer_load_dwordx4 v8, s[8:11], s78 offen lds
    v_mfma_f32_16x16x32_bf16 v[104:107], a[16:19], a[112:115], v[104:107]
    ds_read_b64_tr_b16 a[38:39], v32 offset:12800
    v_mfma_f32_16x16x32_bf16 v[104:107], a[20:23], a[116:119], v[104:107]
    ds_read_b64_tr_b16 a[40:41], v33 offset:0
    v_mfma_f32_16x16x32_bf16 v[108:111], a[20:23], a[124:127], v[108:111]
    ds_read_b64_tr_b16 a[42:43], v33 offset:512
    v_mfma_f32_16x16x32_bf16 v[108:111], a[16:19], a[120:123], v[108:111]
    buffer_load_dwordx4 v9, s[8:11], s78 offen offset:1024 lds
    s_waitcnt lgkmcnt(3)
    v_mfma_f32_16x16x32_bf16 v[124:127], a[24:27], a[120:123], v[124:127]
    ds_read_b64_tr_b16 a[44:45], v33 offset:12288
    v_mfma_f32_16x16x32_bf16 v[124:127], a[28:31], a[124:127], v[124:127]
    ds_read_b64_tr_b16 a[46:47], v33 offset:12800
    v_mfma_f32_16x16x32_bf16 v[120:123], a[28:31], a[116:119], v[120:123]
    buffer_load_dwordx4 v10, s[8:11], s78 offen offset:2048 lds
    s_add_u32 m0, s39, 122880
    v_mfma_f32_16x16x32_bf16 v[120:123], a[24:27], a[112:115], v[120:123]
    v_mfma_f32_16x16x32_bf16 v[116:119], a[24:27], a[104:107], v[116:119]
    v_mfma_f32_16x16x32_bf16 v[116:119], a[28:31], a[108:111], v[116:119]
    s_waitcnt vmcnt(15) lgkmcnt(0)
    s_barrier
    v_mfma_f32_16x16x32_bf16 v[112:115], a[28:31], a[100:103], v[112:115]
    ds_read_b64_tr_b16 a[0:1], v28 offset:40960
    v_mfma_f32_16x16x32_bf16 v[112:115], a[24:27], a[96:99], v[112:115]
    ds_read_b64_tr_b16 a[2:3], v28 offset:41472
    v_mfma_f32_16x16x32_bf16 v[128:131], a[32:35], a[96:99], v[128:131]
    ds_read_b128 a[128:131], v40 offset:40960
    v_mfma_f32_16x16x32_bf16 v[128:131], a[36:39], a[100:103], v[128:131]
    buffer_load_dwordx4 v14, s[4:7], s79 offen lds
    v_mfma_f32_16x16x32_bf16 v[132:135], a[36:39], a[108:111], v[132:135]
    ds_read_b64_tr_b16 a[4:5], v28 offset:53248
    v_mfma_f32_16x16x32_bf16 v[132:135], a[32:35], a[104:107], v[132:135]
    ds_read_b64_tr_b16 a[6:7], v28 offset:53760
    v_mfma_f32_16x16x32_bf16 v[136:139], a[32:35], a[112:115], v[136:139]
    ds_read_b128 a[132:135], v41 offset:40960
    v_mfma_f32_16x16x32_bf16 v[136:139], a[36:39], a[116:119], v[136:139]
    buffer_load_dwordx4 v15, s[4:7], s79 offen offset:1024 lds
    s_add_u32 m0, s47, 122880
    v_mfma_f32_16x16x32_bf16 v[140:143], a[36:39], a[124:127], v[140:143]
    ds_read_b128 a[136:139], v42 offset:40960
    v_mfma_f32_16x16x32_bf16 v[140:143], a[32:35], a[120:123], v[140:143]
A_PG0:
    s_cbranch_execz A_WARM_END
    ds_read_b128 a[140:143], v43 offset:40960
    v_mfma_f32_16x16x32_bf16 v[156:159], a[40:43], a[120:123], v[156:159]
    ds_read_b128 a[144:147], v40 offset:49152
    v_mfma_f32_16x16x32_bf16 v[156:159], a[44:47], a[124:127], v[156:159]
    buffer_load_dwordx4 v11, s[8:11], s78 offen lds
    v_mfma_f32_16x16x32_bf16 v[152:155], a[44:47], a[116:119], v[152:155]
    ds_read_b128 a[148:151], v41 offset:49152
    v_mfma_f32_16x16x32_bf16 v[152:155], a[40:43], a[112:115], v[152:155]
    ds_read_b128 a[152:155], v42 offset:49152
    v_mfma_f32_16x16x32_bf16 v[148:151], a[40:43], a[104:107], v[148:151]
    ds_read_b128 a[156:159], v43 offset:49152
    v_mfma_f32_16x16x32_bf16 v[148:151], a[44:47], a[108:111], v[148:151]
    buffer_load_dwordx4 v12, s[8:11], s78 offen offset:1024 lds
    v_mfma_f32_16x16x32_bf16 v[144:147], a[44:47], a[100:103], v[144:147]
    buffer_load_dwordx4 v13, s[8:11], s78 offen offset:2048 lds
    s_add_u32 m0, s48, 122880
    v_mfma_f32_16x16x32_bf16 v[144:147], a[40:43], a[96:99], v[144:147]
    s_waitcnt lgkmcnt(1)
    v_mfma_f32_16x16x32_bf16 v[64:67], a[0:3], a[128:131], v[64:67]
    ds_read_b64_tr_b16 a[8:9], v29 offset:40960
    v_mfma_f32_16x16x32_bf16 v[64:67], a[4:7], a[132:135], v[64:67]
    ds_read_b64_tr_b16 a[10:11], v29 offset:41472
    v_mfma_f32_16x16x32_bf16 v[68:71], a[4:7], a[140:143], v[68:71]
    ds_read_b64_tr_b16 a[12:13], v29 offset:53248
    v_mfma_f32_16x16x32_bf16 v[68:71], a[0:3], a[136:139], v[68:71]
    buffer_load_dwordx4 v16, s[4:7], s79 offen lds
    v_mfma_f32_16x16x32_bf16 v[72:75], a[0:3], a[144:147], v[72:75]
    ds_read_b64_tr_b16 a[14:15], v29 offset:53760
    v_mfma_f32_16x16x32_bf16 v[72:75], a[4:7], a[148:151], v[72:75]
    ds_read_b64_tr_b16 a[16:17], v30 offset:40960
    s_waitcnt lgkmcnt(3)
    v_mfma_f32_16x16x32_bf16 v[76:79], a[4:7], a[156:159], v[76:79]
    ds_read_b64_tr_b16 a[18:19], v30 offset:41472
    v_mfma_f32_16x16x32_bf16 v[76:79], a[0:3], a[152:155], v[76:79]
    buffer_load_dwordx4 v17, s[4:7], s79 offen offset:1024 lds
    s_add_u32 m0, s38, 0
    v_mfma_f32_16x16x32_bf16 v[92:95], a[8:11], a[152:155], v[92:95]
    ds_read_b64_tr_b16 a[20:21], v30 offset:53248
    s_waitcnt lgkmcnt(3)
    v_mfma_f32_16x16x32_bf16 v[92:95], a[12:15], a[156:159], v[92:95]
    ds_read_b64_tr_b16 a[22:23], v30 offset:53760
    v_mfma_f32_16x16x32_bf16 v[88:91], a[12:15], a[148:151], v[88:91]
    ds_read_b64_tr_b16 a[24:25], v31 offset:40960
    v_mfma_f32_16x16x32_bf16 v[88:91], a[8:11], a[144:147], v[88:91]
    buffer_load_dwordx4 v8, s[8:11], s80 offen lds
    v_mfma_f32_16x16x32_bf16 v[84:87], a[8:11], a[136:139], v[84:87]
    ds_read_b64_tr_b16 a[26:27], v31 offset:41472
    v_mfma_f32_16x16x32_bf16 v[84:87], a[12:15], a[140:143], v[84:87]
    ds_read_b64_tr_b16 a[28:29], v31 offset:53248
    v_mfma_f32_16x16x32_bf16 v[80:83], a[12:15], a[132:135], v[80:83]
    ds_read_b64_tr_b16 a[30:31], v31 offset:53760
    v_mfma_f32_16x16x32_bf16 v[80:83], a[8:11], a[128:131], v[80:83]
    buffer_load_dwordx4 v9, s[8:11], s80 offen offset:1024 lds
    s_waitcnt lgkmcnt(3)
    v_mfma_f32_16x16x32_bf16 v[96:99], a[16:19], a[128:131], v[96:99]
    ds_read_b64_tr_b16 a[32:33], v32 offset:40960
    v_mfma_f32_16x16x32_bf16 v[96:99], a[20:23], a[132:135], v[96:99]
    ds_read_b64_tr_b16 a[34:35], v32 offset:41472
    v_mfma_f32_16x16x32_bf16 v[100:103], a[20:23], a[140:143], v[100:103]
    ds_read_b64_tr_b16 a[36:37], v32 offset:53248
    v_mfma_f32_16x16x32_bf16 v[100:103], a[16:19], a[136:139], v[100:103]
    buffer_load_dwordx4 v10, s[8:11], s80 offen offset:2048 lds
    s_add_u32 m0, s39, 0
    v_mfma_f32_16x16x32_bf16 v[104:107], a[16:19], a[144:147], v[104:107]
    ds_read_b64_tr_b16 a[38:39], v32 offset:53760
    v_mfma_f32_16x16x32_bf16 v[104:107], a[20:23], a[148:151], v[104:107]
    ds_read_b64_tr_b16 a[40:41], v33 offset:40960
    v_mfma_f32_16x16x32_bf16 v[108:111], a[20:23], a[156:159], v[108:111]
    ds_read_b64_tr_b16 a[42:43], v33 offset:41472
    v_mfma_f32_16x16x32_bf16 v[108:111], a[16:19], a[152:155], v[108:111]
    buffer_load_dwordx4 v14, s[4:7], s81 offen lds
    s_waitcnt lgkmcnt(3)
    v_mfma_f32_16x16x32_bf16 v[124:127], a[24:27], a[152:155], v[124:127]
    ds_read_b64_tr_b16 a[44:45], v33 offset:53248
    v_mfma_f32_16x16x32_bf16 v[124:127], a[28:31], a[156:159], v[124:127]
    ds_read_b64_tr_b16 a[46:47], v33 offset:53760
    v_mfma_f32_16x16x32_bf16 v[120:123], a[28:31], a[148:151], v[120:123]
    buffer_load_dwordx4 v15, s[4:7], s81 offen offset:1024 lds
    s_add_u32 m0, s47, 0
    v_mfma_f32_16x16x32_bf16 v[120:123], a[24:27], a[144:147], v[120:123]
    v_mfma_f32_16x16x32_bf16 v[116:119], a[24:27], a[136:139], v[116:119]
    v_mfma_f32_16x16x32_bf16 v[116:119], a[28:31], a[140:143], v[116:119]
    s_waitcnt vmcnt(17) lgkmcnt(0)
    s_barrier
    v_mfma_f32_16x16x32_bf16 v[112:115], a[28:31], a[132:135], v[112:115]
    ds_read_b64_tr_b16 a[0:1], v34 offset:0
    v_mfma_f32_16x16x32_bf16 v[112:115], a[24:27], a[128:131], v[112:115]
    ds_read_b64_tr_b16 a[2:3], v34 offset:512
    v_mfma_f32_16x16x32_bf16 v[128:131], a[32:35], a[128:131], v[128:131]
    ds_read_b128 a[96:99], v44 offset:0
    v_mfma_f32_16x16x32_bf16 v[128:131], a[36:39], a[132:135], v[128:131]
    buffer_load_dwordx4 v11, s[8:11], s80 offen lds
    v_mfma_f32_16x16x32_bf16 v[132:135], a[36:39], a[140:143], v[132:135]
    ds_read_b64_tr_b16 a[4:5], v34 offset:12288
    v_mfma_f32_16x16x32_bf16 v[132:135], a[32:35], a[136:139], v[132:135]
    ds_read_b64_tr_b16 a[6:7], v34 offset:12800
    v_mfma_f32_16x16x32_bf16 v[136:139], a[32:35], a[144:147], v[136:139]
    ds_read_b128 a[100:103], v45 offset:0
    v_mfma_f32_16x16x32_bf16 v[136:139], a[36:39], a[148:151], v[136:139]
    buffer_load_dwordx4 v12, s[8:11], s80 offen offset:1024 lds
    v_mfma_f32_16x16x32_bf16 v[140:143], a[36:39], a[156:159], v[140:143]
    ds_read_b128 a[104:107], v46 offset:0
    v_mfma_f32_16x16x32_bf16 v[140:143], a[32:35], a[152:155], v[140:143]
    ds_read_b128 a[108:111], v47 offset:0
    v_mfma_f32_16x16x32_bf16 v[156:159], a[40:43], a[152:155], v[156:159]
    ds_read_b128 a[112:115], v44 offset:8192
    v_mfma_f32_16x16x32_bf16 v[156:159], a[44:47], a[156:159], v[156:159]
    buffer_load_dwordx4 v13, s[8:11], s80 offen offset:2048 lds
    s_add_u32 m0, s48, 0
    v_mfma_f32_16x16x32_bf16 v[152:155], a[44:47], a[148:151], v[152:155]
    ds_read_b128 a[116:119], v45 offset:8192
    v_mfma_f32_16x16x32_bf16 v[152:155], a[40:43], a[144:147], v[152:155]
    ds_read_b128 a[120:123], v46 offset:8192
    v_mfma_f32_16x16x32_bf16 v[148:151], a[40:43], a[136:139], v[148:151]
    ds_read_b128 a[124:127], v47 offset:8192
    v_mfma_f32_16x16x32_bf16 v[148:151], a[44:47], a[140:143], v[148:151]
    buffer_load_dwordx4 v16, s[4:7], s81 offen lds
    v_mfma_f32_16x16x32_bf16 v[144:147], a[44:47], a[132:135], v[144:147]
    s_load_dwordx2 s[88:89], s[24:25], 0
    v_mfma_f32_16x16x32_bf16 v[144:147], a[40:43], a[128:131], v[144:147]
    buffer_load_dwordx4 v17, s[4:7], s81 offen offset:1024 lds
    s_add_u32 m0, s38, 40960
    s_waitcnt lgkmcnt(1)
    v_mfma_f32_16x16x32_bf16 v[64:67], a[0:3], a[96:99], v[64:67]
    ds_read_b64_tr_b16 a[8:9], v35 offset:0
    v_mfma_f32_16x16x32_bf16 v[64:67], a[4:7], a[100:103], v[64:67]
    ds_read_b64_tr_b16 a[10:11], v35 offset:512
    v_mfma_f32_16x16x32_bf16 v[68:71], a[4:7], a[108:111], v[68:71]
    ds_read_b64_tr_b16 a[12:13], v35 offset:12288
    v_mfma_f32_16x16x32_bf16 v[68:71], a[0:3], a[104:107], v[68:71]
    buffer_load_dwordx4 v8, s[8:11], s82 offen lds
    v_mfma_f32_16x16x32_bf16 v[72:75], a[0:3], a[112:115], v[72:75]
    ds_read_b64_tr_b16 a[14:15], v35 offset:12800
    v_mfma_f32_16x16x32_bf16 v[72:75], a[4:7], a[116:119], v[72:75]
    ds_read_b64_tr_b16 a[16:17], v36 offset:0
    s_waitcnt lgkmcnt(3)
    v_mfma_f32_16x16x32_bf16 v[76:79], a[4:7], a[124:127], v[76:79]
    ds_read_b64_tr_b16 a[18:19], v36 offset:512
    v_mfma_f32_16x16x32_bf16 v[76:79], a[0:3], a[120:123], v[76:79]
    buffer_load_dwordx4 v9, s[8:11], s82 offen offset:1024 lds
    v_mfma_f32_16x16x32_bf16 v[92:95], a[8:11], a[120:123], v[92:95]
    ds_read_b64_tr_b16 a[20:21], v36 offset:12288
    s_waitcnt lgkmcnt(3)
    v_mfma_f32_16x16x32_bf16 v[92:95], a[12:15], a[124:127], v[92:95]
    ds_read_b64_tr_b16 a[22:23], v36 offset:12800
    v_mfma_f32_16x16x32_bf16 v[88:91], a[12:15], a[116:119], v[88:91]
    ds_read_b64_tr_b16 a[24:25], v37 offset:0
    v_mfma_f32_16x16x32_bf16 v[88:91], a[8:11], a[112:115], v[88:91]
    buffer_load_dwordx4 v10, s[8:11], s82 offen offset:2048 lds
    s_add_u32 m0, s39, 40960
    v_mfma_f32_16x16x32_bf16 v[84:87], a[8:11], a[104:107], v[84:87]
    ds_read_b64_tr_b16 a[26:27], v37 offset:512
    v_mfma_f32_16x16x32_bf16 v[84:87], a[12:15], a[108:111], v[84:87]
    ds_read_b64_tr_b16 a[28:29], v37 offset:12288
    v_mfma_f32_16x16x32_bf16 v[80:83], a[12:15], a[100:103], v[80:83]
    ds_read_b64_tr_b16 a[30:31], v37 offset:12800
    v_mfma_f32_16x16x32_bf16 v[80:83], a[8:11], a[96:99], v[80:83]
    buffer_load_dwordx4 v14, s[4:7], s83 offen lds
    s_waitcnt lgkmcnt(3)
    v_mfma_f32_16x16x32_bf16 v[96:99], a[16:19], a[96:99], v[96:99]
    ds_read_b64_tr_b16 a[32:33], v38 offset:0
    v_mfma_f32_16x16x32_bf16 v[96:99], a[20:23], a[100:103], v[96:99]
    ds_read_b64_tr_b16 a[34:35], v38 offset:512
    v_mfma_f32_16x16x32_bf16 v[100:103], a[20:23], a[108:111], v[100:103]
    ds_read_b64_tr_b16 a[36:37], v38 offset:12288
    v_mfma_f32_16x16x32_bf16 v[100:103], a[16:19], a[104:107], v[100:103]
    buffer_load_dwordx4 v15, s[4:7], s83 offen offset:1024 lds
    s_add_u32 m0, s47, 40960
    v_mfma_f32_16x16x32_bf16 v[104:107], a[16:19], a[112:115], v[104:107]
    ds_read_b64_tr_b16 a[38:39], v38 offset:12800
    v_mfma_f32_16x16x32_bf16 v[104:107], a[20:23], a[116:119], v[104:107]
    ds_read_b64_tr_b16 a[40:41], v39 offset:0
    v_mfma_f32_16x16x32_bf16 v[108:111], a[20:23], a[124:127], v[108:111]
    ds_read_b64_tr_b16 a[42:43], v39 offset:512
    v_mfma_f32_16x16x32_bf16 v[108:111], a[16:19], a[120:123], v[108:111]
    buffer_load_dwordx4 v11, s[8:11], s82 offen lds
    s_waitcnt lgkmcnt(3)
    v_mfma_f32_16x16x32_bf16 v[124:127], a[24:27], a[120:123], v[124:127]
    ds_read_b64_tr_b16 a[44:45], v39 offset:12288
    v_mfma_f32_16x16x32_bf16 v[124:127], a[28:31], a[124:127], v[124:127]
    ds_read_b64_tr_b16 a[46:47], v39 offset:12800
    v_mfma_f32_16x16x32_bf16 v[120:123], a[28:31], a[116:119], v[120:123]
    buffer_load_dwordx4 v12, s[8:11], s82 offen offset:1024 lds
    v_mfma_f32_16x16x32_bf16 v[120:123], a[24:27], a[112:115], v[120:123]
    v_mfma_f32_16x16x32_bf16 v[116:119], a[24:27], a[104:107], v[116:119]
    v_mfma_f32_16x16x32_bf16 v[116:119], a[28:31], a[108:111], v[116:119]
    s_waitcnt vmcnt(17) lgkmcnt(0)
    s_barrier
    v_mfma_f32_16x16x32_bf16 v[112:115], a[28:31], a[100:103], v[112:115]
    ds_read_b64_tr_b16 a[0:1], v34 offset:40960
    v_mfma_f32_16x16x32_bf16 v[112:115], a[24:27], a[96:99], v[112:115]
    ds_read_b64_tr_b16 a[2:3], v34 offset:41472
    v_mfma_f32_16x16x32_bf16 v[128:131], a[32:35], a[96:99], v[128:131]
    ds_read_b128 a[128:131], v44 offset:40960
    v_mfma_f32_16x16x32_bf16 v[128:131], a[36:39], a[100:103], v[128:131]
    buffer_load_dwordx4 v13, s[8:11], s82 offen offset:2048 lds
    s_add_u32 m0, s48, 40960
    v_mfma_f32_16x16x32_bf16 v[132:135], a[36:39], a[108:111], v[132:135]
    ds_read_b64_tr_b16 a[4:5], v34 offset:53248
    v_mfma_f32_16x16x32_bf16 v[132:135], a[32:35], a[104:107], v[132:135]
    ds_read_b64_tr_b16 a[6:7], v34 offset:53760
    v_mfma_f32_16x16x32_bf16 v[136:139], a[32:35], a[112:115], v[136:139]
    ds_read_b128 a[132:135], v45 offset:40960
    v_mfma_f32_16x16x32_bf16 v[136:139], a[36:39], a[116:119], v[136:139]
    buffer_load_dwordx4 v16, s[4:7], s83 offen lds
    v_mfma_f32_16x16x32_bf16 v[140:143], a[36:39], a[124:127], v[140:143]
    ds_read_b128 a[136:139], v46 offset:40960
    v_mfma_f32_16x16x32_bf16 v[140:143], a[32:35], a[120:123], v[140:143]
    ds_read_b128 a[140:143], v47 offset:40960
    v_mfma_f32_16x16x32_bf16 v[156:159], a[40:43], a[120:123], v[156:159]
    ds_read_b128 a[144:147], v44 offset:49152
    v_mfma_f32_16x16x32_bf16 v[156:159], a[44:47], a[124:127], v[156:159]
    buffer_load_dwordx4 v17, s[4:7], s83 offen offset:1024 lds
    s_add_u32 m0, s54, 81920
    v_mfma_f32_16x16x32_bf16 v[152:155], a[44:47], a[116:119], v[152:155]
    ds_read_b128 a[148:151], v45 offset:49152
    v_mfma_f32_16x16x32_bf16 v[152:155], a[40:43], a[112:115], v[152:155]
    ds_read_b128 a[152:155], v46 offset:49152
    v_mfma_f32_16x16x32_bf16 v[148:151], a[40:43], a[104:107], v[148:151]
    ds_read_b128 a[156:159], v47 offset:49152
    v_mfma_f32_16x16x32_bf16 v[148:151], a[44:47], a[108:111], v[148:151]
    buffer_load_dwordx4 v26, s[12:15], s55 offen lds
    v_mfma_f32_16x16x32_bf16 v[144:147], a[44:47], a[100:103], v[144:147]
    v_mov_b32 v18, s88
    v_mov_b32 v19, s89
    s_cmp_eq_u32 s88, 0
    s_cbranch_scc1 A_NON_SLOW
A_NON_OK:
    s_mov_b64 exec, 1
    buffer_store_dwordx2 v[18:19], off, s[16:19], s53 sc1
    s_mov_b64 exec, -1
    v_mfma_f32_16x16x32_bf16 v[144:147], a[40:43], a[96:99], v[144:147]
    buffer_load_dwordx4 v27, s[12:15], s55 offen offset:1024 lds
    s_add_u32 m0, s54, 90112
    s_waitcnt lgkmcnt(1)
    v_mfma_f32_16x16x32_bf16 v[64:67], a[0:3], a[128:131], v[64:67]
    ds_read_b64_tr_b16 a[8:9], v35 offset:40960
    v_mfma_f32_16x16x32_bf16 v[64:67], a[4:7], a[132:135], v[64:67]
    ds_read_b64_tr_b16 a[10:11], v35 offset:41472
    v_mfma_f32_16x16x32_bf16 v[68:71], a[4:7], a[140:143], v[68:71]
    ds_read_b64_tr_b16 a[12:13], v35 offset:53248
    v_mfma_f32_16x16x32_bf16 v[68:71], a[0:3], a[136:139], v[68:71]
    buffer_load_dwordx4 v26, s[12:15], s56 offen lds
    v_mfma_f32_16x16x32_bf16 v[72:75], a[0:3], a[144:147], v[72:75]
    ds_read_b64_tr_b16 a[14:15], v35 offset:53760
    v_mfma_f32_16x16x32_bf16 v[72:75], a[4:7], a[148:151], v[72:75]
    ds_read_b64_tr_b16 a[16:17], v36 offset:40960
    s_waitcnt lgkmcnt(3)
    v_mfma_f32_16x16x32_bf16 v[76:79], a[4:7], a[156:159], v[76:79]
    ds_read_b64_tr_b16 a[18:19], v36 offset:41472
    v_mfma_f32_16x16x32_bf16 v[76:79], a[0:3], a[152:155], v[76:79]
    buffer_load_dwordx4 v27, s[12:15], s56 offen offset:1024 lds
    s_add_u32 m0, s54, 98304
    v_mfma_f32_16x16x32_bf16 v[92:95], a[8:11], a[152:155], v[92:95]
    ds_read_b64_tr_b16 a[20:21], v36 offset:53248
    s_waitcnt lgkmcnt(3)
    v_mfma_f32_16x16x32_bf16 v[92:95], a[12:15], a[156:159], v[92:95]
    ds_read_b64_tr_b16 a[22:23], v36 offset:53760
    v_mfma_f32_16x16x32_bf16 v[88:91], a[12:15], a[148:151], v[88:91]
    ds_read_b64_tr_b16 a[24:25], v37 offset:40960
    v_mfma_f32_16x16x32_bf16 v[88:91], a[8:11], a[144:147], v[88:91]
    buffer_load_dwordx4 v26, s[12:15], s57 offen lds
    v_mfma_f32_16x16x32_bf16 v[84:87], a[8:11], a[136:139], v[84:87]
    ds_read_b64_tr_b16 a[26:27], v37 offset:41472
    v_mfma_f32_16x16x32_bf16 v[84:87], a[12:15], a[140:143], v[84:87]
    ds_read_b64_tr_b16 a[28:29], v37 offset:53248
    v_mfma_f32_16x16x32_bf16 v[80:83], a[12:15], a[132:135], v[80:83]
    ds_read_b64_tr_b16 a[30:31], v37 offset:53760
    v_mfma_f32_16x16x32_bf16 v[80:83], a[8:11], a[128:131], v[80:83]
    buffer_load_dwordx4 v27, s[12:15], s57 offen offset:1024 lds
    s_add_u32 m0, s54, 122880
    s_waitcnt lgkmcnt(3)
    v_mfma_f32_16x16x32_bf16 v[96:99], a[16:19], a[128:131], v[96:99]
    ds_read_b64_tr_b16 a[32:33], v38 offset:40960
    v_mfma_f32_16x16x32_bf16 v[96:99], a[20:23], a[132:135], v[96:99]
    ds_read_b64_tr_b16 a[34:35], v38 offset:41472
    v_mfma_f32_16x16x32_bf16 v[100:103], a[20:23], a[140:143], v[100:103]
    ds_read_b64_tr_b16 a[36:37], v38 offset:53248
    v_mfma_f32_16x16x32_bf16 v[100:103], a[16:19], a[136:139], v[100:103]
    v_mfma_f32_16x16x32_bf16 v[104:107], a[16:19], a[144:147], v[104:107]
    ds_read_b64_tr_b16 a[38:39], v38 offset:53760
    v_mfma_f32_16x16x32_bf16 v[104:107], a[20:23], a[148:151], v[104:107]
    ds_read_b64_tr_b16 a[40:41], v39 offset:40960
    v_mfma_f32_16x16x32_bf16 v[108:111], a[20:23], a[156:159], v[108:111]
    ds_read_b64_tr_b16 a[42:43], v39 offset:41472
    v_mfma_f32_16x16x32_bf16 v[108:111], a[16:19], a[152:155], v[108:111]
    s_waitcnt lgkmcnt(3)
    v_mfma_f32_16x16x32_bf16 v[124:127], a[24:27], a[152:155], v[124:127]
    ds_read_b64_tr_b16 a[44:45], v39 offset:53248
    v_mfma_f32_16x16x32_bf16 v[124:127], a[28:31], a[156:159], v[124:127]
    ds_read_b64_tr_b16 a[46:47], v39 offset:53760
    v_mfma_f32_16x16x32_bf16 v[120:123], a[28:31], a[148:151], v[120:123]
    v_mfma_f32_16x16x32_bf16 v[120:123], a[24:27], a[144:147], v[120:123]
    v_mfma_f32_16x16x32_bf16 v[116:119], a[24:27], a[136:139], v[116:119]
    v_mfma_f32_16x16x32_bf16 v[116:119], a[28:31], a[140:143], v[116:119]
    s_waitcnt vmcnt(16) lgkmcnt(0)
    s_barrier
    buffer_load_dwordx4 v26, s[12:15], s58 offen lds
    v_mfma_f32_16x16x32_bf16 v[112:115], a[28:31], a[132:135], v[112:115]
    ds_read_b64_tr_b16 a[0:1], v28 offset:0
    v_mfma_f32_16x16x32_bf16 v[112:115], a[24:27], a[128:131], v[112:115]
    ds_read_b64_tr_b16 a[2:3], v28 offset:512
    v_mfma_f32_16x16x32_bf16 v[128:131], a[32:35], a[128:131], v[128:131]
    ds_read_b128 a[96:99], v40 offset:0
    v_mfma_f32_16x16x32_bf16 v[128:131], a[36:39], a[132:135], v[128:131]
    buffer_load_dwordx4 v27, s[12:15], s58 offen offset:1024 lds
    s_add_u32 m0, s54, 131072
    v_mfma_f32_16x16x32_bf16 v[132:135], a[36:39], a[140:143], v[132:135]
    ds_read_b64_tr_b16 a[4:5], v28 offset:12288
    v_mfma_f32_16x16x32_bf16 v[132:135], a[32:35], a[136:139], v[132:135]
    ds_read_b64_tr_b16 a[6:7], v28 offset:12800
    v_mfma_f32_16x16x32_bf16 v[136:139], a[32:35], a[144:147], v[136:139]
    ds_read_b128 a[100:103], v41 offset:0
    v_mfma_f32_16x16x32_bf16 v[136:139], a[36:39], a[148:151], v[136:139]
    buffer_load_dwordx4 v26, s[12:15], s59 offen lds
    v_mfma_f32_16x16x32_bf16 v[140:143], a[36:39], a[156:159], v[140:143]
    ds_read_b128 a[104:107], v42 offset:0
    v_mfma_f32_16x16x32_bf16 v[140:143], a[32:35], a[152:155], v[140:143]
    ds_read_b128 a[108:111], v43 offset:0
    v_mfma_f32_16x16x32_bf16 v[156:159], a[40:43], a[152:155], v[156:159]
    ds_read_b128 a[112:115], v40 offset:8192
    v_mfma_f32_16x16x32_bf16 v[156:159], a[44:47], a[156:159], v[156:159]
    buffer_load_dwordx4 v27, s[12:15], s59 offen offset:1024 lds
    s_add_u32 m0, s54, 139264
    v_mfma_f32_16x16x32_bf16 v[152:155], a[44:47], a[148:151], v[152:155]
    ds_read_b128 a[116:119], v41 offset:8192
    ds_read_b64_tr_b16 a[8:9], v29 offset:0
    v_mfma_f32_16x16x32_bf16 v[152:155], a[40:43], a[144:147], v[152:155]
    ds_read_b128 a[120:123], v42 offset:8192
    ds_read_b64_tr_b16 a[10:11], v29 offset:512
    v_mfma_f32_16x16x32_bf16 v[148:151], a[40:43], a[136:139], v[148:151]
    ds_read_b128 a[124:127], v43 offset:8192
    v_mfma_f32_16x16x32_bf16 v[148:151], a[44:47], a[140:143], v[148:151]
    ds_read_b64_tr_b16 a[12:13], v29 offset:12288
    buffer_load_dwordx4 v26, s[12:15], s60 offen lds
    v_mfma_f32_16x16x32_bf16 v[144:147], a[44:47], a[132:135], v[144:147]
    ds_read_b64_tr_b16 a[14:15], v29 offset:12800
    v_mfma_f32_16x16x32_bf16 v[144:147], a[40:43], a[128:131], v[144:147]
    buffer_load_dwordx4 v27, s[12:15], s60 offen offset:1024 lds
    s_waitcnt lgkmcnt(3)
    v_mfma_f32_16x16x32_bf16 v[64:67], a[0:3], a[96:99], v[64:67]
    ds_read_b64_tr_b16 a[16:17], v30 offset:0
    ds_read_b64_tr_b16 a[18:19], v30 offset:512
    v_mfma_f32_16x16x32_bf16 v[64:67], a[4:7], a[100:103], v[64:67]
    ds_read_b64_tr_b16 a[20:21], v30 offset:12288
    v_mfma_f32_16x16x32_bf16 v[68:71], a[4:7], a[108:111], v[68:71]
    ds_read_b64_tr_b16 a[22:23], v30 offset:12800
    ds_read_b64_tr_b16 a[24:25], v31 offset:0
    v_mfma_f32_16x16x32_bf16 v[68:71], a[0:3], a[104:107], v[68:71]
    ds_read_b64_tr_b16 a[26:27], v31 offset:512
    v_mfma_f32_16x16x32_bf16 v[84:87], a[8:11], a[104:107], v[84:87]
    ds_read_b64_tr_b16 a[28:29], v31 offset:12288
    ds_read_b64_tr_b16 a[30:31], v31 offset:12800
    s_waitcnt lgkmcnt(6)
    v_mfma_f32_16x16x32_bf16 v[84:87], a[12:15], a[108:111], v[84:87]
    ds_read_b64_tr_b16 a[32:33], v32 offset:0
    v_mfma_f32_16x16x32_bf16 v[80:83], a[12:15], a[100:103], v[80:83]
    ds_read_b64_tr_b16 a[34:35], v32 offset:512
    ds_read_b64_tr_b16 a[36:37], v32 offset:12288
    v_mfma_f32_16x16x32_bf16 v[80:83], a[8:11], a[96:99], v[80:83]
    ds_read_b64_tr_b16 a[38:39], v32 offset:12800
    v_mfma_f32_16x16x32_bf16 v[96:99], a[16:19], a[96:99], v[96:99]
    ds_read_b64_tr_b16 a[40:41], v33 offset:0
    ds_read_b64_tr_b16 a[42:43], v33 offset:512
    s_waitcnt lgkmcnt(6)
    v_mfma_f32_16x16x32_bf16 v[96:99], a[20:23], a[100:103], v[96:99]
    ds_read_b64_tr_b16 a[44:45], v33 offset:12288
    v_mfma_f32_16x16x32_bf16 v[100:103], a[20:23], a[108:111], v[100:103]
    ds_read_b64_tr_b16 a[46:47], v33 offset:12800
    v_mfma_f32_16x16x32_bf16 v[100:103], a[16:19], a[104:107], v[100:103]
    v_mfma_f32_16x16x32_bf16 v[116:119], a[24:27], a[104:107], v[116:119]
    v_mfma_f32_16x16x32_bf16 v[116:119], a[28:31], a[108:111], v[116:119]
    s_waitcnt vmcnt(12) lgkmcnt(0)
    s_barrier
    v_mfma_f32_16x16x32_bf16 v[112:115], a[28:31], a[100:103], v[112:115]
    ds_read_b64_tr_b16 a[48:49], v28 offset:40960
    ds_read_b64_tr_b16 a[50:51], v28 offset:41472
    v_mfma_f32_16x16x32_bf16 v[112:115], a[24:27], a[96:99], v[112:115]
    ds_read_b128 a[128:131], v40 offset:40960
    v_mfma_f32_16x16x32_bf16 v[128:131], a[32:35], a[96:99], v[128:131]
    ds_read_b64_tr_b16 a[52:53], v28 offset:53248
    v_mfma_f32_16x16x32_bf16 v[128:131], a[36:39], a[100:103], v[128:131]
    ds_read_b64_tr_b16 a[54:55], v28 offset:53760
    v_mfma_f32_16x16x32_bf16 v[132:135], a[36:39], a[108:111], v[132:135]
    ds_read_b128 a[132:135], v41 offset:40960
    v_mfma_f32_16x16x32_bf16 v[132:135], a[32:35], a[104:107], v[132:135]
    ds_read_b128 a[136:139], v42 offset:40960
    ds_read_b128 a[140:143], v43 offset:40960
    v_mfma_f32_16x16x32_bf16 v[148:151], a[40:43], a[104:107], v[148:151]
    ds_read_b64_tr_b16 a[56:57], v29 offset:40960
    v_mfma_f32_16x16x32_bf16 v[148:151], a[44:47], a[108:111], v[148:151]
    ds_read_b64_tr_b16 a[58:59], v29 offset:41472
    v_mfma_f32_16x16x32_bf16 v[144:147], a[44:47], a[100:103], v[144:147]
    ds_read_b64_tr_b16 a[60:61], v29 offset:53248
    v_mfma_f32_16x16x32_bf16 v[144:147], a[40:43], a[96:99], v[144:147]
    ds_read_b64_tr_b16 a[62:63], v29 offset:53760
    s_waitcnt lgkmcnt(4)
    v_mfma_f32_16x16x32_bf16 v[64:67], a[48:51], a[128:131], v[64:67]
    ds_read_b64_tr_b16 a[64:65], v30 offset:40960
    ds_read_b64_tr_b16 a[66:67], v30 offset:41472
    v_mfma_f32_16x16x32_bf16 v[64:67], a[52:55], a[132:135], v[64:67]
    ds_read_b64_tr_b16 a[68:69], v30 offset:53248
    v_mfma_f32_16x16x32_bf16 v[68:71], a[52:55], a[140:143], v[68:71]
    ds_read_b64_tr_b16 a[70:71], v30 offset:53760
    v_mfma_f32_16x16x32_bf16 v[68:71], a[48:51], a[136:139], v[68:71]
    ds_read_b64_tr_b16 a[72:73], v31 offset:40960
    ds_read_b64_tr_b16 a[74:75], v31 offset:41472
    s_waitcnt lgkmcnt(6)
    v_mfma_f32_16x16x32_bf16 v[84:87], a[56:59], a[136:139], v[84:87]
    ds_read_b64_tr_b16 a[76:77], v31 offset:53248
    v_mfma_f32_16x16x32_bf16 v[84:87], a[60:63], a[140:143], v[84:87]
    ds_read_b64_tr_b16 a[78:79], v31 offset:53760
    v_mfma_f32_16x16x32_bf16 v[80:83], a[60:63], a[132:135], v[80:83]
    ds_read_b64_tr_b16 a[80:81], v32 offset:40960
    ds_read_b64_tr_b16 a[82:83], v32 offset:41472
    v_mfma_f32_16x16x32_bf16 v[80:83], a[56:59], a[128:131], v[80:83]
    ds_read_b64_tr_b16 a[84:85], v32 offset:53248
    s_waitcnt lgkmcnt(5)
    v_mfma_f32_16x16x32_bf16 v[96:99], a[64:67], a[128:131], v[96:99]
    ds_read_b64_tr_b16 a[86:87], v32 offset:53760
    v_mfma_f32_16x16x32_bf16 v[96:99], a[68:71], a[132:135], v[96:99]
    ds_read_b64_tr_b16 a[88:89], v33 offset:40960
    ds_read_b64_tr_b16 a[90:91], v33 offset:41472
    v_mfma_f32_16x16x32_bf16 v[100:103], a[68:71], a[140:143], v[100:103]
    ds_read_b64_tr_b16 a[92:93], v33 offset:53248
    v_mfma_f32_16x16x32_bf16 v[100:103], a[64:67], a[136:139], v[100:103]
    ds_read_b64_tr_b16 a[94:95], v33 offset:53760
    v_mfma_f32_16x16x32_bf16 v[116:119], a[72:75], a[136:139], v[116:119]
    ds_read_b128 a[144:147], v40 offset:49152
    s_waitcnt lgkmcnt(5)
    v_mfma_f32_16x16x32_bf16 v[116:119], a[76:79], a[140:143], v[116:119]
    ds_read_b128 a[148:151], v41 offset:49152
    v_mfma_f32_16x16x32_bf16 v[112:115], a[76:79], a[132:135], v[112:115]
    ds_read_b128 a[152:155], v42 offset:49152
    v_cvt_pk_bf16_f32 v160, v64, v65
    v_cvt_pk_bf16_f32 v161, v66, v67
    v_mfma_f32_16x16x32_bf16 v[112:115], a[72:75], a[128:131], v[112:115]
    ds_read_b128 a[156:159], v43 offset:49152
    v_cvt_pk_bf16_f32 v162, v80, v81
    v_mfma_f32_16x16x32_bf16 v[128:131], a[80:83], a[128:131], v[128:131]
    v_cvt_pk_bf16_f32 v163, v82, v83
    v_mfma_f32_16x16x32_bf16 v[128:131], a[84:87], a[132:135], v[128:131]
    v_cvt_pk_bf16_f32 v164, v68, v69
    v_cvt_pk_bf16_f32 v165, v70, v71
    v_mfma_f32_16x16x32_bf16 v[132:135], a[84:87], a[140:143], v[132:135]
    v_cvt_pk_bf16_f32 v166, v84, v85
    v_mfma_f32_16x16x32_bf16 v[132:135], a[80:83], a[136:139], v[132:135]
    v_cvt_pk_bf16_f32 v167, v86, v87
    s_waitcnt lgkmcnt(0)
    v_mfma_f32_16x16x32_bf16 v[148:151], a[88:91], a[136:139], v[148:151]
    v_mfma_f32_16x16x32_bf16 v[148:151], a[92:95], a[140:143], v[148:151]
    v_mfma_f32_16x16x32_bf16 v[144:147], a[92:95], a[132:135], v[144:147]
    v_cvt_pk_bf16_f32 v168, v96, v97
    v_cvt_pk_bf16_f32 v169, v98, v99
    v_mfma_f32_16x16x32_bf16 v[144:147], a[88:91], a[128:131], v[144:147]
    v_cvt_pk_bf16_f32 v170, v112, v113
    v_cvt_pk_bf16_f32 v171, v114, v115
    v_mfma_f32_16x16x32_bf16 v[72:75], a[0:3], a[112:115], v[72:75]
    v_cvt_pk_bf16_f32 v172, v100, v101
    v_cvt_pk_bf16_f32 v173, v102, v103
    v_mfma_f32_16x16x32_bf16 v[72:75], a[4:7], a[116:119], v[72:75]
    s_waitcnt vmcnt(6) lgkmcnt(0)
    s_barrier
    v_cvt_pk_bf16_f32 v174, v116, v117
    v_cvt_pk_bf16_f32 v175, v118, v119
    v_mfma_f32_16x16x32_bf16 v[76:79], a[4:7], a[124:127], v[76:79]
    ds_read_b64 v[208:209], v48 offset:0
    ds_read_b64 v[210:211], v49 offset:0
    v_mfma_f32_16x16x32_bf16 v[76:79], a[0:3], a[120:123], v[76:79]
    ds_read_b64 v[220:221], v48 offset:2048
    ds_read_b64 v[222:223], v49 offset:2048
    v_mfma_f32_16x16x32_bf16 v[92:95], a[8:11], a[120:123], v[92:95]
    ds_read_b64 v[212:213], v50 offset:0
    ds_read_b64 v[214:215], v51 offset:0
    v_mfma_f32_16x16x32_bf16 v[92:95], a[12:15], a[124:127], v[92:95]
    ds_read_b64 v[224:225], v50 offset:2048
    ds_read_b64 v[226:227], v51 offset:2048
    s_waitcnt lgkmcnt(6)
    v_mfma_f32_16x16x32_bf16 v[184:187], v[208:211], v[160:163], 0
    ds_read_b64 v[216:217], v52 offset:0
    ds_read_b64 v[218:219], v53 offset:0
    s_waitcnt lgkmcnt(4)
    v_mfma_f32_16x16x32_bf16 v[184:187], v[212:215], v[168:171], v[184:187]
    ds_read_b64 v[228:229], v52 offset:2048
    ds_read_b64 v[230:231], v53 offset:2048
    v_mfma_f32_16x16x32_bf16 v[188:191], v[220:223], v[160:163], 0
    v_cvt_pk_bf16_f32 v176, v128, v129
    v_cvt_pk_bf16_f32 v177, v130, v131
    s_waitcnt lgkmcnt(4)
    v_mfma_f32_16x16x32_bf16 v[188:191], v[224:227], v[168:171], v[188:191]
    v_cvt_pk_bf16_f32 v178, v144, v145
    v_cvt_pk_bf16_f32 v179, v146, v147
    v_mfma_f32_16x16x32_bf16 v[192:195], v[208:211], v[164:167], 0
    v_cvt_pk_bf16_f32 v180, v132, v133
    v_cvt_pk_bf16_f32 v181, v134, v135
    v_mfma_f32_16x16x32_bf16 v[192:195], v[212:215], v[172:175], v[192:195]
    v_cvt_pk_bf16_f32 v182, v148, v149
    v_cvt_pk_bf16_f32 v183, v150, v151
    v_mfma_f32_16x16x32_bf16 v[196:199], v[220:223], v[164:167], 0
    s_mov_b32 s42, 0x3dd53b95
    v_mfma_f32_16x16x32_bf16 v[196:199], v[224:227], v[172:175], v[196:199]
    s_waitcnt lgkmcnt(0)
    v_mfma_f32_16x16x32_bf16 v[184:187], v[216:219], v[176:179], v[184:187]
    v_mfma_f32_16x16x32_bf16 v[188:191], v[228:231], v[176:179], v[188:191]
    v_mfma_f32_16x16x32_bf16 v[192:195], v[216:219], v[180:183], v[192:195]
    v_mfma_f32_16x16x32_bf16 v[196:199], v[228:231], v[180:183], v[196:199]
    v_mfma_f32_16x16x32_bf16 v[88:91], a[12:15], a[116:119], v[88:91]
    v_mfma_f32_16x16x32_bf16 v[88:91], a[8:11], a[112:115], v[88:91]
    v_mfma_f32_16x16x32_bf16 v[104:107], a[16:19], a[112:115], v[104:107]
    v_mfma_f32_16x16x32_bf16 v[104:107], a[20:23], a[116:119], v[104:107]
    v_mfma_f32_16x16x32_bf16 v[108:111], a[20:23], a[124:127], v[108:111]
    v_mfma_f32_16x16x32_bf16 v[108:111], a[16:19], a[120:123], v[108:111]
    ds_write_b128 v54, v[184:187] offset:0
    ds_write_b128 v54, v[188:191] offset:1024
    v_mfma_f32_16x16x32_bf16 v[124:127], a[24:27], a[120:123], v[124:127]
    v_mfma_f32_16x16x32_bf16 v[124:127], a[28:31], a[124:127], v[124:127]
    v_mfma_f32_16x16x32_bf16 v[120:123], a[28:31], a[116:119], v[120:123]
    v_mfma_f32_16x16x32_bf16 v[120:123], a[24:27], a[112:115], v[120:123]
    s_waitcnt lgkmcnt(0)
    s_barrier
    ds_read_b128 v[200:203], v55 offset:0
    ds_read_b128 v[204:207], v55 offset:1024
    v_mfma_f32_16x16x32_bf16 v[136:139], a[32:35], a[112:115], v[136:139]
    v_mfma_f32_16x16x32_bf16 v[136:139], a[36:39], a[116:119], v[136:139]
    v_mfma_f32_16x16x32_bf16 v[140:143], a[36:39], a[124:127], v[140:143]
    v_mfma_f32_16x16x32_bf16 v[140:143], a[32:35], a[120:123], v[140:143]
    v_mfma_f32_16x16x32_bf16 v[156:159], a[40:43], a[120:123], v[156:159]
    s_waitcnt lgkmcnt(0)
    v_add_f32 v192, v192, v200
    v_add_f32 v193, v193, v201
    v_add_f32 v194, v194, v202
    v_add_f32 v195, v195, v203
    v_mfma_f32_16x16x32_bf16 v[156:159], a[44:47], a[124:127], v[156:159]
    v_add_f32 v196, v196, v204
    v_add_f32 v197, v197, v205
    v_add_f32 v198, v198, v206
    v_add_f32 v199, v199, v207
    v_mfma_f32_16x16x32_bf16 v[152:155], a[44:47], a[116:119], v[152:155]
    v_max3_f32 v22, v192, v193, v194
    v_max3_f32 v23, v195, v196, v197
    v_max3_f32 v22, v22, v198, v199
    v_max_f32 v22, v22, v23
A_PG1:
    s_cbranch_execz A_WARM_END
    v_mfma_f32_16x16x32_bf16 v[152:155], a[40:43], a[112:115], v[152:155]
    v_mov_b32 v23, v22
    v_mfma_f32_16x16x32_bf16 v[72:75], a[48:51], a[144:147], v[72:75]
    s_nop 0
    v_permlane16_swap_b32 v22, v23
    v_max_f32 v22, v22, v23
    v_mov_b32 v23, v22
    v_mfma_f32_16x16x32_bf16 v[72:75], a[52:55], a[148:151], v[72:75]
    s_nop 0
    v_permlane32_swap_b32 v22, v23
    v_max_f32 v22, v22, v23
    v_mul_f32 v22, s42, v22
    v_mfma_f32_16x16x32_bf16 v[76:79], a[52:55], a[156:159], v[76:79]
    v_fma_f32 v192, v192, s42, -v22
    v_fma_f32 v193, v193, s42, -v22
    v_fma_f32 v194, v194, s42, -v22
    v_fma_f32 v195, v195, s42, -v22
    v_mfma_f32_16x16x32_bf16 v[76:79], a[48:51], a[152:155], v[76:79]
    v_fma_f32 v196, v196, s42, -v22
    v_fma_f32 v197, v197, s42, -v22
    v_fma_f32 v198, v198, s42, -v22
    v_fma_f32 v199, v199, s42, -v22
    v_mfma_f32_16x16x32_bf16 v[92:95], a[56:59], a[152:155], v[92:95]
    v_exp_f32 v192, v192
    v_exp_f32 v193, v193
    v_mfma_f32_16x16x32_bf16 v[92:95], a[60:63], a[156:159], v[92:95]
    v_exp_f32 v194, v194
    v_add_f32 v22, v192, v193
    v_exp_f32 v195, v195
    v_mfma_f32_16x16x32_bf16 v[88:91], a[60:63], a[148:151], v[88:91]
    v_add_f32 v22, v22, v194
    v_exp_f32 v196, v196
    v_add_f32 v22, v22, v195
    v_mfma_f32_16x16x32_bf16 v[88:91], a[56:59], a[144:147], v[88:91]
    v_exp_f32 v197, v197
    v_add_f32 v22, v22, v196
    v_exp_f32 v198, v198
    v_mfma_f32_16x16x32_bf16 v[104:107], a[64:67], a[144:147], v[104:107]
    v_add_f32 v22, v22, v197
    v_exp_f32 v199, v199
    v_add_f32 v22, v22, v198
    v_mfma_f32_16x16x32_bf16 v[104:107], a[68:71], a[148:151], v[104:107]
    v_add_f32 v22, v22, v199
    v_mov_b32 v23, v22
    v_mfma_f32_16x16x32_bf16 v[108:111], a[68:71], a[156:159], v[108:111]
    s_nop 0
    v_permlane16_swap_b32 v22, v23
    v_add_f32 v22, v22, v23
    v_mov_b32 v23, v22
    v_mfma_f32_16x16x32_bf16 v[108:111], a[64:67], a[152:155], v[108:111]
    s_nop 0
    v_permlane32_swap_b32 v22, v23
    v_add_f32 v22, v22, v23
    v_rcp_f32 v22, v22
    v_mfma_f32_16x16x32_bf16 v[124:127], a[72:75], a[152:155], v[124:127]
    v_mul_f32 v192, v192, v22
    v_mul_f32 v193, v193, v22
    v_mul_f32 v194, v194, v22
    v_mul_f32 v195, v195, v22
    v_mfma_f32_16x16x32_bf16 v[124:127], a[76:79], a[156:159], v[124:127]
    s_waitcnt vmcnt(0) lgkmcnt(0)
    s_barrier
    v_cvt_pk_bf16_f32 v60, |v192|, |v193|
    v_mul_f32 v196, v196, v22
    v_mul_f32 v197, v197, v22
    v_cvt_pk_bf16_f32 v61, |v194|, |v195|
    v_mfma_f32_16x16x32_bf16 v[120:123], a[76:79], a[148:151], v[120:123]
    v_mul_f32 v198, v198, v22
    v_mul_f32 v199, v199, v22
    v_cvt_pk_bf16_f32 v62, |v196|, |v197|
    v_cvt_pk_bf16_f32 v63, |v198|, |v199|
    v_mfma_f32_16x16x32_bf16 v[120:123], a[72:75], a[144:147], v[120:123]
    buffer_store_dwordx4 v[60:63], v20, s[16:19], s52 offen
    v_mfma_f32_16x16x32_bf16 v[136:139], a[80:83], a[144:147], v[136:139]
    ds_read_b64 v[232:233], v48 offset:40960
    ds_read_b64 v[234:235], v49 offset:40960
    v_mfma_f32_16x16x32_bf16 v[136:139], a[84:87], a[148:151], v[136:139]
    ds_read_b64 v[244:245], v48 offset:43008
    v_mfma_f32_16x16x32_bf16 v[140:143], a[84:87], a[156:159], v[140:143]
    ds_read_b64 v[246:247], v49 offset:43008
    ds_read_b64 v[236:237], v50 offset:40960
    v_mfma_f32_16x16x32_bf16 v[140:143], a[80:83], a[152:155], v[140:143]
    ds_read_b64 v[238:239], v51 offset:40960
    v_cvt_pk_bf16_f32 v160, v72, v73
    v_cvt_pk_bf16_f32 v161, v74, v75
    v_mfma_f32_16x16x32_bf16 v[156:159], a[88:91], a[152:155], v[156:159]
    ds_read_b64 v[248:249], v50 offset:43008
    ds_read_b64 v[250:251], v51 offset:43008
    v_cvt_pk_bf16_f32 v162, v88, v89
    v_cvt_pk_bf16_f32 v163, v90, v91
    v_mfma_f32_16x16x32_bf16 v[156:159], a[92:95], a[156:159], v[156:159]
    ds_read_b64 v[240:241], v52 offset:40960
    v_cvt_pk_bf16_f32 v164, v76, v77
    v_mfma_f32_16x16x32_bf16 v[152:155], a[92:95], a[148:151], v[152:155]
    ds_read_b64 v[242:243], v53 offset:40960
    ds_read_b64 v[252:253], v52 offset:43008
    v_cvt_pk_bf16_f32 v165, v78, v79
    v_cvt_pk_bf16_f32 v166, v92, v93
    v_mfma_f32_16x16x32_bf16 v[152:155], a[88:91], a[144:147], v[152:155]
    ds_read_b64 v[254:255], v53 offset:43008
    v_cvt_pk_bf16_f32 v167, v94, v95
    s_waitcnt lgkmcnt(6)
    v_mfma_f32_16x16x32_bf16 v[184:187], v[232:235], v[160:163], 0
    v_cvt_pk_bf16_f32 v168, v104, v105
    v_cvt_pk_bf16_f32 v169, v106, v107
    v_mfma_f32_16x16x32_bf16 v[188:191], v[244:247], v[160:163], 0
    v_cvt_pk_bf16_f32 v170, v120, v121
    v_cvt_pk_bf16_f32 v171, v122, v123
    v_mfma_f32_16x16x32_bf16 v[192:195], v[232:235], v[164:167], 0
    v_cvt_pk_bf16_f32 v172, v108, v109
    v_cvt_pk_bf16_f32 v173, v110, v111
    v_mfma_f32_16x16x32_bf16 v[196:199], v[244:247], v[164:167], 0
    v_cvt_pk_bf16_f32 v174, v124, v125
    v_cvt_pk_bf16_f32 v175, v126, v127
    v_mfma_f32_16x16x32_bf16 v[184:187], v[236:239], v[168:171], v[184:187]
    v_cvt_pk_bf16_f32 v176, v136, v137
    v_cvt_pk_bf16_f32 v177, v138, v139
    s_waitcnt lgkmcnt(0)
    v_mfma_f32_16x16x32_bf16 v[188:191], v[248:251], v[168:171], v[188:191]
    v_cvt_pk_bf16_f32 v178, v152, v153
    v_cvt_pk_bf16_f32 v179, v154, v155
    v_mfma_f32_16x16x32_bf16 v[192:195], v[236:239], v[172:175], v[192:195]
    v_cvt_pk_bf16_f32 v180, v140, v141
    v_cvt_pk_bf16_f32 v181, v142, v143
    v_mfma_f32_16x16x32_bf16 v[196:199], v[248:251], v[172:175], v[196:199]
    v_cvt_pk_bf16_f32 v182, v156, v157
    v_cvt_pk_bf16_f32 v183, v158, v159
    v_mfma_f32_16x16x32_bf16 v[184:187], v[240:243], v[176:179], v[184:187]
    v_mfma_f32_16x16x32_bf16 v[188:191], v[252:255], v[176:179], v[188:191]
    v_mfma_f32_16x16x32_bf16 v[192:195], v[240:243], v[180:183], v[192:195]
    v_mfma_f32_16x16x32_bf16 v[196:199], v[252:255], v[180:183], v[196:199]
    s_nop 5
    ds_write_b128 v54, v[184:187] offset:8192
    ds_write_b128 v54, v[188:191] offset:9216
    s_waitcnt lgkmcnt(0)
    s_barrier
    ds_read_b128 v[200:203], v55 offset:8192
    ds_read_b128 v[204:207], v55 offset:9216
    s_waitcnt lgkmcnt(0)
    v_pk_add_f32 v[192:193], v[192:193], v[200:201]
    v_pk_add_f32 v[194:195], v[194:195], v[202:203]
    v_pk_add_f32 v[196:197], v[196:197], v[204:205]
    v_pk_add_f32 v[198:199], v[198:199], v[206:207]
    v_max3_f32 v22, v192, v193, v194
    v_max3_f32 v23, v195, v196, v197
    v_max3_f32 v22, v22, v198, v199
    v_max_f32 v22, v22, v23
    v_mov_b32 v23, v22
    s_nop 1
    v_permlane16_swap_b32 v22, v23
    v_max_f32 v22, v22, v23
    v_mov_b32 v23, v22
    s_nop 1
    v_permlane32_swap_b32 v22, v23
    v_max_f32 v22, v22, v23
    v_mul_f32 v22, s42, v22
    v_fma_f32 v192, v192, s42, -v22
    v_fma_f32 v193, v193, s42, -v22
    v_fma_f32 v194, v194, s42, -v22
    v_fma_f32 v195, v195, s42, -v22
    v_fma_f32 v196, v196, s42, -v22
    v_fma_f32 v197, v197, s42, -v22
    v_fma_f32 v198, v198, s42, -v22
    v_fma_f32 v199, v199, s42, -v22
    v_exp_f32 v192, v192
    v_exp_f32 v193, v193
    v_exp_f32 v194, v194
    v_exp_f32 v195, v195
    v_exp_f32 v196, v196
    v_exp_f32 v197, v197
    v_exp_f32 v198, v198
    v_exp_f32 v199, v199
    v_pk_add_f32 v[200:201], v[192:193], v[194:195]
    v_pk_add_f32 v[202:203], v[196:197], v[198:199]
    v_pk_add_f32 v[200:201], v[200:201], v[202:203]
    v_add_f32 v22, v200, v201
    v_mov_b32 v23, v22
    s_nop 1
    v_permlane16_swap_b32 v22, v23
    v_add_f32 v22, v22, v23
    v_mov_b32 v23, v22
    s_nop 1
    v_permlane32_swap_b32 v22, v23
    v_add_f32 v22, v22, v23
    v_rcp_f32 v22, v22
    s_nop 0
    v_pk_mul_f32 v[192:193], v[192:193], v[22:23] op_sel_hi:[1,0]
    v_pk_mul_f32 v[194:195], v[194:195], v[22:23] op_sel_hi:[1,0]
    v_pk_mul_f32 v[196:197], v[196:197], v[22:23] op_sel_hi:[1,0]
    v_pk_mul_f32 v[198:199], v[198:199], v[22:23] op_sel_hi:[1,0]
    v_cvt_pk_bf16_f32 v204, |v192|, |v193|
    v_cvt_pk_bf16_f32 v205, |v194|, |v195|
    v_cvt_pk_bf16_f32 v206, |v196|, |v197|
    v_cvt_pk_bf16_f32 v207, |v198|, |v199|
    buffer_store_dwordx4 v[204:207], v20, s[16:19], s61 offen
    buffer_store_dwordx4 v[60:63], v56, s[16:19], s52 offen sc1
    buffer_store_dwordx4 v[204:207], v56, s[16:19], s61 offen sc1
    s_mov_b32 s76, s53
    s_and_b32 s40, s28, 1
    s_lshr_b32 s41, s28, 1
    s_lshl_b32 s33, s30, 2
    s_add_u32 s33, s33, s40
    s_lshl_b32 s42, s30, 1
    s_add_u32 s42, s42, s40
    s_lshl_b32 s42, s42, 2
    s_add_u32 s42, s42, s41
    s_lshl_b32 s42, s42, 2
    s_add_u32 s42, s42, s29
    s_lshl_b32 s42, s42, 9
    s_add_u32 s49, s42, 1114112
    s_lshl_b32 s42, s33, 2
    s_add_u32 s42, s42, s41
    s_lshl_b32 s42, s42, 2
    s_add_u32 s42, s42, s29
    s_mul_i32 s42, s42, 20480
    s_mul_i32 s43, s32, 640
    s_add_u32 s42, s42, s43
    s_add_u32 s64, s42, 2097152
    s_add_u32 s65, s42, 2099712
    s_add_u32 s66, s42, 2102272
    s_add_u32 s67, s42, 2104832
    s_add_u32 s68, s42, 2107392
    s_add_u32 s69, s42, 2109952
    s_add_u32 s70, s42, 2112512
    s_add_u32 s71, s42, 2115072
    s_lshl_b32 s42, s33, 3
    s_add_u32 s42, s42, s41
    s_mul_i32 s50, s42, 5120
    s_mul_i32 s42, s29, 320
    s_add_u32 s50, s50, s42
    s_mul_i32 s42, s32, 80
    s_add_u32 s50, s50, s42
    v_and_b32 v1, 3, v0
    v_mul_u32_u24 v8, 1280, v1
    v_lshrrev_b32 v2, 2, v0
    v_lshl_add_u32 v8, v2, 3, v8
    v_add_u32 v9, 20480, v8
    v_lshlrev_b32 v10, 5, v0
    v_add_u32 v11, 655360, v20
    s_mov_b32 s43, 0xffff0000
    s_add_u32 s51, s49, 65536
    s_add_u32 s52, s50, 81920
    s_waitcnt vmcnt(0)
    s_mov_b64 exec, 1
    buffer_store_dwordx2 v[18:19], off, s[16:19], s76 offset:8 sc1
    s_mov_b64 exec, -1
    s_cmp_lg_u32 s32, 0
    s_cbranch_scc1 R_GO0
    s_mov_b64 exec, 0xffff
R_POLL0:
    buffer_load_dwordx2 v[22:23], v10, s[16:19], s49 offen sc1
    s_sub_u32 s46, s46, 1
    s_cbranch_scc1 DONE
    s_waitcnt vmcnt(0)
    v_cmpx_ne_u64 vcc, v[22:23], v[18:19]
    s_cbranch_execz R_GO0
    s_sleep 1
    s_branch R_POLL0
R_GO0:
    s_mov_b32 exec_lo, -1
    s_mov_b32 exec_hi, 0xff
    s_barrier
    buffer_load_dwordx4 v[64:67], v20, s[16:19], s64 offen sc1
    buffer_load_dwordx4 v[68:71], v20, s[16:19], s65 offen sc1
    buffer_load_dwordx4 v[72:75], v20, s[16:19], s66 offen sc1
    buffer_load_dwordx4 v[76:79], v20, s[16:19], s67 offen sc1
    buffer_load_dwordx4 v[80:83], v20, s[16:19], s68 offen sc1
    buffer_load_dwordx4 v[84:87], v20, s[16:19], s69 offen sc1
    buffer_load_dwordx4 v[88:91], v20, s[16:19], s70 offen sc1
    buffer_load_dwordx4 v[92:95], v20, s[16:19], s71 offen sc1
    s_cmp_lg_u32 s32, 0
    s_cbranch_scc1 R_GO1
    s_mov_b64 exec, 0xffff
R_POLL1:
    buffer_load_dwordx2 v[22:23], v10, s[16:19], s51 offen sc1
    s_sub_u32 s46, s46, 1
    s_cbranch_scc1 DONE
    s_waitcnt vmcnt(0)
    v_cmpx_ne_u64 vcc, v[22:23], v[18:19]
    s_cbranch_execz R_GO1
    s_sleep 1
    s_branch R_POLL1
R_GO1:
    s_mov_b32 exec_lo, -1
    s_mov_b32 exec_hi, 0xff
    s_barrier
    buffer_load_dwordx4 v[96:99], v11, s[16:19], s64 offen sc1
    buffer_load_dwordx4 v[100:103], v11, s[16:19], s65 offen sc1
    buffer_load_dwordx4 v[104:107], v11, s[16:19], s66 offen sc1
    buffer_load_dwordx4 v[108:111], v11, s[16:19], s67 offen sc1
    buffer_load_dwordx4 v[112:115], v11, s[16:19], s68 offen sc1
    buffer_load_dwordx4 v[116:119], v11, s[16:19], s69 offen sc1
    buffer_load_dwordx4 v[120:123], v11, s[16:19], s70 offen sc1
    buffer_load_dwordx4 v[124:127], v11, s[16:19], s71 offen sc1
R_SUM0:
    s_waitcnt vmcnt(15)
    v_lshlrev_b32 v132, 16, v64
    v_and_b32 v133, s43, v64
    v_lshlrev_b32 v134, 16, v65
    v_and_b32 v135, s43, v65
    v_lshlrev_b32 v136, 16, v66
    v_and_b32 v137, s43, v66
    v_lshlrev_b32 v138, 16, v67
    v_and_b32 v139, s43, v67
    s_waitcnt vmcnt(14)
    v_lshlrev_b32 v148, 16, v68
    v_and_b32 v149, s43, v68
    v_lshlrev_b32 v150, 16, v69
    v_and_b32 v151, s43, v69
    v_lshlrev_b32 v152, 16, v70
    v_and_b32 v153, s43, v70
    v_lshlrev_b32 v154, 16, v71
    v_and_b32 v155, s43, v71
    v_pk_add_f32 v[132:133], v[132:133], v[148:149]
    v_pk_add_f32 v[134:135], v[134:135], v[150:151]
    v_pk_add_f32 v[136:137], v[136:137], v[152:153]
    v_pk_add_f32 v[138:139], v[138:139], v[154:155]
    s_waitcnt vmcnt(13)
    v_lshlrev_b32 v140, 16, v72
    v_and_b32 v141, s43, v72
    v_lshlrev_b32 v142, 16, v73
    v_and_b32 v143, s43, v73
    v_lshlrev_b32 v144, 16, v74
    v_and_b32 v145, s43, v74
    v_lshlrev_b32 v146, 16, v75
    v_and_b32 v147, s43, v75
    v_pk_add_f32 v[132:133], v[132:133], v[140:141]
    v_pk_add_f32 v[134:135], v[134:135], v[142:143]
    v_pk_add_f32 v[136:137], v[136:137], v[144:145]
    v_pk_add_f32 v[138:139], v[138:139], v[146:147]
    s_waitcnt vmcnt(12)
    v_lshlrev_b32 v148, 16, v76
    v_and_b32 v149, s43, v76
    v_lshlrev_b32 v150, 16, v77
    v_and_b32 v151, s43, v77
    v_lshlrev_b32 v152, 16, v78
    v_and_b32 v153, s43, v78
    v_lshlrev_b32 v154, 16, v79
    v_and_b32 v155, s43, v79
    v_pk_add_f32 v[132:133], v[132:133], v[148:149]
    v_pk_add_f32 v[134:135], v[134:135], v[150:151]
    v_pk_add_f32 v[136:137], v[136:137], v[152:153]
    v_pk_add_f32 v[138:139], v[138:139], v[154:155]
    s_waitcnt vmcnt(11)
    v_lshlrev_b32 v140, 16, v80
    v_and_b32 v141, s43, v80
    v_lshlrev_b32 v142, 16, v81
    v_and_b32 v143, s43, v81
    v_lshlrev_b32 v144, 16, v82
    v_and_b32 v145, s43, v82
    v_lshlrev_b32 v146, 16, v83
    v_and_b32 v147, s43, v83
    v_pk_add_f32 v[132:133], v[132:133], v[140:141]
    v_pk_add_f32 v[134:135], v[134:135], v[142:143]
    v_pk_add_f32 v[136:137], v[136:137], v[144:145]
    v_pk_add_f32 v[138:139], v[138:139], v[146:147]
    s_waitcnt vmcnt(10)
    v_lshlrev_b32 v148, 16, v84
    v_and_b32 v149, s43, v84
    v_lshlrev_b32 v150, 16, v85
    v_and_b32 v151, s43, v85
    v_lshlrev_b32 v152, 16, v86
    v_and_b32 v153, s43, v86
    v_lshlrev_b32 v154, 16, v87
    v_and_b32 v155, s43, v87
    v_pk_add_f32 v[132:133], v[132:133], v[148:149]
    v_pk_add_f32 v[134:135], v[134:135], v[150:151]
    v_pk_add_f32 v[136:137], v[136:137], v[152:153]
    v_pk_add_f32 v[138:139], v[138:139], v[154:155]
    s_waitcnt vmcnt(9)
    v_lshlrev_b32 v140, 16, v88
    v_and_b32 v141, s43, v88
    v_lshlrev_b32 v142, 16, v89
    v_and_b32 v143, s43, v89
    v_lshlrev_b32 v144, 16, v90
    v_and_b32 v145, s43, v90
    v_lshlrev_b32 v146, 16, v91
    v_and_b32 v147, s43, v91
    v_pk_add_f32 v[132:133], v[132:133], v[140:141]
    v_pk_add_f32 v[134:135], v[134:135], v[142:143]
    v_pk_add_f32 v[136:137], v[136:137], v[144:145]
    v_pk_add_f32 v[138:139], v[138:139], v[146:147]
    s_waitcnt vmcnt(8)
    v_lshlrev_b32 v148, 16, v92
    v_and_b32 v149, s43, v92
    v_lshlrev_b32 v150, 16, v93
    v_and_b32 v151, s43, v93
    v_lshlrev_b32 v152, 16, v94
    v_and_b32 v153, s43, v94
    v_lshlrev_b32 v154, 16, v95
    v_and_b32 v155, s43, v95
    v_pk_add_f32 v[132:133], v[132:133], v[148:149]
    v_pk_add_f32 v[134:135], v[134:135], v[150:151]
    v_pk_add_f32 v[136:137], v[136:137], v[152:153]
    v_pk_add_f32 v[138:139], v[138:139], v[154:155]
    v_cvt_pk_bf16_f32 v128, v132, v133
    v_cvt_pk_bf16_f32 v129, v134, v135
    v_cvt_pk_bf16_f32 v130, v136, v137
    v_cvt_pk_bf16_f32 v131, v138, v139
    buffer_store_dwordx2 v[128:129], v8, s[20:23], s50 offen
    buffer_store_dwordx2 v[130:131], v9, s[20:23], s50 offen
R_SUM1:
    s_waitcnt vmcnt(9)
    v_lshlrev_b32 v132, 16, v96
    v_and_b32 v133, s43, v96
    v_lshlrev_b32 v134, 16, v97
    v_and_b32 v135, s43, v97
    v_lshlrev_b32 v136, 16, v98
    v_and_b32 v137, s43, v98
    v_lshlrev_b32 v138, 16, v99
    v_and_b32 v139, s43, v99
    s_waitcnt vmcnt(8)
    v_lshlrev_b32 v148, 16, v100
    v_and_b32 v149, s43, v100
    v_lshlrev_b32 v150, 16, v101
    v_and_b32 v151, s43, v101
    v_lshlrev_b32 v152, 16, v102
    v_and_b32 v153, s43, v102
    v_lshlrev_b32 v154, 16, v103
    v_and_b32 v155, s43, v103
    v_pk_add_f32 v[132:133], v[132:133], v[148:149]
    v_pk_add_f32 v[134:135], v[134:135], v[150:151]
    v_pk_add_f32 v[136:137], v[136:137], v[152:153]
    v_pk_add_f32 v[138:139], v[138:139], v[154:155]
    s_waitcnt vmcnt(7)
    v_lshlrev_b32 v140, 16, v104
    v_and_b32 v141, s43, v104
    v_lshlrev_b32 v142, 16, v105
    v_and_b32 v143, s43, v105
    v_lshlrev_b32 v144, 16, v106
    v_and_b32 v145, s43, v106
    v_lshlrev_b32 v146, 16, v107
    v_and_b32 v147, s43, v107
    v_pk_add_f32 v[132:133], v[132:133], v[140:141]
    v_pk_add_f32 v[134:135], v[134:135], v[142:143]
    v_pk_add_f32 v[136:137], v[136:137], v[144:145]
    v_pk_add_f32 v[138:139], v[138:139], v[146:147]
    s_waitcnt vmcnt(6)
    v_lshlrev_b32 v148, 16, v108
    v_and_b32 v149, s43, v108
    v_lshlrev_b32 v150, 16, v109
    v_and_b32 v151, s43, v109
    v_lshlrev_b32 v152, 16, v110
    v_and_b32 v153, s43, v110
    v_lshlrev_b32 v154, 16, v111
    v_and_b32 v155, s43, v111
    v_pk_add_f32 v[132:133], v[132:133], v[148:149]
    v_pk_add_f32 v[134:135], v[134:135], v[150:151]
    v_pk_add_f32 v[136:137], v[136:137], v[152:153]
    v_pk_add_f32 v[138:139], v[138:139], v[154:155]
    s_waitcnt vmcnt(5)
    v_lshlrev_b32 v140, 16, v112
    v_and_b32 v141, s43, v112
    v_lshlrev_b32 v142, 16, v113
    v_and_b32 v143, s43, v113
    v_lshlrev_b32 v144, 16, v114
    v_and_b32 v145, s43, v114
    v_lshlrev_b32 v146, 16, v115
    v_and_b32 v147, s43, v115
    v_pk_add_f32 v[132:133], v[132:133], v[140:141]
    v_pk_add_f32 v[134:135], v[134:135], v[142:143]
    v_pk_add_f32 v[136:137], v[136:137], v[144:145]
    v_pk_add_f32 v[138:139], v[138:139], v[146:147]
    s_waitcnt vmcnt(4)
    v_lshlrev_b32 v148, 16, v116
    v_and_b32 v149, s43, v116
    v_lshlrev_b32 v150, 16, v117
    v_and_b32 v151, s43, v117
    v_lshlrev_b32 v152, 16, v118
    v_and_b32 v153, s43, v118
    v_lshlrev_b32 v154, 16, v119
    v_and_b32 v155, s43, v119
    v_pk_add_f32 v[132:133], v[132:133], v[148:149]
    v_pk_add_f32 v[134:135], v[134:135], v[150:151]
    v_pk_add_f32 v[136:137], v[136:137], v[152:153]
    v_pk_add_f32 v[138:139], v[138:139], v[154:155]
    s_waitcnt vmcnt(3)
    v_lshlrev_b32 v140, 16, v120
    v_and_b32 v141, s43, v120
    v_lshlrev_b32 v142, 16, v121
    v_and_b32 v143, s43, v121
    v_lshlrev_b32 v144, 16, v122
    v_and_b32 v145, s43, v122
    v_lshlrev_b32 v146, 16, v123
    v_and_b32 v147, s43, v123
    v_pk_add_f32 v[132:133], v[132:133], v[140:141]
    v_pk_add_f32 v[134:135], v[134:135], v[142:143]
    v_pk_add_f32 v[136:137], v[136:137], v[144:145]
    v_pk_add_f32 v[138:139], v[138:139], v[146:147]
    s_waitcnt vmcnt(2)
    v_lshlrev_b32 v148, 16, v124
    v_and_b32 v149, s43, v124
    v_lshlrev_b32 v150, 16, v125
    v_and_b32 v151, s43, v125
    v_lshlrev_b32 v152, 16, v126
    v_and_b32 v153, s43, v126
    v_lshlrev_b32 v154, 16, v127
    v_and_b32 v155, s43, v127
    v_pk_add_f32 v[132:133], v[132:133], v[148:149]
    v_pk_add_f32 v[134:135], v[134:135], v[150:151]
    v_pk_add_f32 v[136:137], v[136:137], v[152:153]
    v_pk_add_f32 v[138:139], v[138:139], v[154:155]
    v_cvt_pk_bf16_f32 v156, v132, v133
    v_cvt_pk_bf16_f32 v157, v134, v135
    v_cvt_pk_bf16_f32 v158, v136, v137
    v_cvt_pk_bf16_f32 v159, v138, v139
    buffer_store_dwordx2 v[156:157], v8, s[20:23], s52 offen
    buffer_store_dwordx2 v[158:159], v9, s[20:23], s52 offen
    s_mov_b64 exec, -1
    s_endpgm
.p2align 12
B_MAIN:
    s_load_dwordx2 s[12:13], s[0:1], 8
    s_load_dwordx2 s[20:21], s[0:1], 40
    s_load_dwordx2 s[24:25], s[0:1], 48
    s_load_dwordx2 s[16:17], s[0:1], 56
    s_mov_b32 s14, 6291456
    s_mov_b32 s15, 0x20000
    s_mov_b32 s18, 268435456
    s_mov_b32 s19, 0x20000
    s_mov_b32 s22, 655360
    s_mov_b32 s23, 0x20000
    s_mov_b32 s26, 256
    s_mov_b32 s27, 0x20000
    s_mov_b32 s46, 200000
    s_waitcnt lgkmcnt(0)
    s_lshl_b32 s40, s2, 2
    s_add_u32 s40, s40, s32
    s_cmp_lg_u32 s40, 515
    s_cbranch_scc1 B_NOEP
    s_mov_b32 s40, 1249280
    s_load_dwordx2 s[42:43], s[16:17], s40
    s_waitcnt lgkmcnt(0)
    s_add_u32 s42, s42, 0x9e3779b8
    s_or_b32 s42, s42, 1
    s_add_u32 s43, s43, 0x7f4a7c15
    v_mov_b32 v24, s42
    v_mov_b32 v25, s43
    s_mov_b64 exec, 1
    buffer_store_dwordx2 v[24:25], off, s[24:27], 0 sc1
    buffer_store_dwordx2 v[24:25], off, s[16:19], s40 sc1
    s_mov_b64 exec, -1
B_NOEP:
    s_and_b32 s50, s32, 1
    s_lshr_b32 s51, s32, 1
    v_mul_u32_u24 v5, 3072, v4
    v_and_b32 v21, 3, v0
    v_lshl_add_u32 v5, v21, 3, v5
    v_lshrrev_b32 v6, 5, v0
    v_mul_u32_u24 v6, 6144, v6
    v_lshl_add_u32 v6, v21, 3, v6
    v_bfe_u32 v1, v0, 2, 2
    v_lshl_add_u32 v5, v1, 7, v5
    v_lshl_add_u32 v6, v1, 6, v6
    v_bfe_u32 v1, v0, 3, 2
    v_lshl_add_u32 v5, v1, 5, v5
    v_bfe_u32 v1, v0, 4, 1
    v_lshl_add_u32 v6, v1, 9, v6
    v_lshlrev_b32 v20, 4, v0
    s_lshl_b32 s40, s50, 10
    v_add_u32 v26, s40, v5
    v_xor_b32 v27, 32, v26
    v_xor_b32 v28, 64, v26
    v_xor_b32 v29, 96, v26
    v_and_b32 v1, 1, v4
    v_xor_b32 v1, s50, v1
    v_lshl_add_u32 v6, v1, 5, v6
    v_add_u32 v30, 2048, v6
    v_add_u32 v31, 81920, v26
    v_add_u32 v32, 81920, v27
    v_add_u32 v33, 81920, v28
    v_add_u32 v34, 81920, v29
    v_add_u32 v35, 81920, v30
    v_and_b32 v21, 15, v0
    v_lshrrev_b32 v5, 1, v21
    v_xor_b32 v5, v5, v4
    v_lshlrev_b32 v5, 4, v5
    v_lshl_add_u32 v5, v21, 7, v5
    s_lshl_b32 s40, s51, 12
    s_add_u32 s40, s40, 24576
    v_add_u32 v36, s40, v5
    v_xor_b32 v37, 64, v36
    v_add_u32 v38, 81920, v36
    v_add_u32 v39, 81920, v37
    v_bfe_u32 v1, v0, 2, 2
    v_mul_u32_u24 v13, 81920, v1
    v_lshl_add_u32 v13, v4, 6, v13
    v_and_b32 v1, 3, v0
    v_lshl_add_u32 v13, v1, 4, v13
    s_lshl_b32 s43, s30, 2
    s_add_u32 s43, s43, s51
    s_lshl_b32 s40, s43, 5
    s_add_u32 s40, s40, s34
    s_lshl_b32 s60, s40, 11
    s_add_u32 s61, s60, 131072
    s_bfe_u32 s41, s36, 0x40000
    s_and_b32 s41, s41, 3
    s_add_u32 s41, s41, s40
    s_lshl_b32 s53, s41, 11
    s_bfe_u32 s41, s36, 0x40004
    s_and_b32 s41, s41, 3
    s_add_u32 s41, s41, s40
    s_lshl_b32 s54, s41, 11
    s_bfe_u32 s41, s36, 0x40008
    s_and_b32 s41, s41, 3
    s_add_u32 s41, s41, s40
    s_lshl_b32 s55, s41, 11
    s_bfe_u32 s41, s36, 0x4000c
    s_and_b32 s41, s41, 3
    s_add_u32 s41, s41, s40
    s_lshl_b32 s56, s41, 11
    s_lshl_b32 s40, s43, 4
    s_add_u32 s40, s40, s29
    s_lshl_b32 s40, s40, 3
    s_add_u32 s40, s40, s28
    s_mul_i32 s40, s40, 2560
    s_add_u32 s40, s40, 2097152
    s_lshl_b32 s41, s50, 1
    s_add_u32 s41, s41, s49
    s_lshl_b32 s41, s41, 9
    s_add_u32 s57, s40, s41
    s_xor_b32 s41, s49, 1
    s_lshl_b32 s41, s41, 3
    s_add_u32 s41, s41, s50
    s_lshl_b32 s41, s41, 8
    s_add_u32 s58, s40, s41
    s_lshl_b32 s40, s30, 1
    s_add_u32 s40, s40, s51
    s_lshl_b32 s41, s40, 3
    s_add_u32 s41, s41, s28
    s_lshl_b32 s41, s41, 7
    s_add_u32 s52, s41, 1048576
    s_lshl_b32 s40, s40, 4
    s_add_u32 s40, s40, s29
    s_lshl_b32 s40, s40, 4
    s_lshl_b32 s41, s28, 1
    s_add_u32 s40, s40, s41
    s_add_u32 s40, s40, s50
    s_lshl_b32 s40, s40, 5
    s_add_u32 s59, s40, 1114112
    v_and_b32 v1, 7, v0
    v_lshlrev_b32 v4, 4, v1
    v_lshlrev_b32 v5, 10, v1
    v_and_b32 v1, 3, v0
    v_lshlrev_b32 v6, 11, v1
    v_add_u32 v2, 131072, v20
    v_add_u32 v3, 655360, v13
    s_bfe_u32 s40, s36, 0x40004
    s_and_b32 s41, s40, 3
    s_lshr_b32 s40, s40, 2
    s_mul_i32 s42, s41, 3
    s_add_u32 s42, s42, s40
    s_mul_i32 s42, s42, 81920
    s_add_u32 s66, s42, s44
    s_mul_i32 s42, s41, 96
    s_add_u32 s42, s42, s40
    s_lshl_b32 s42, s42, 7
    s_add_u32 s67, s42, s45
    s_bfe_u32 s40, s36, 0x40008
    s_and_b32 s41, s40, 3
    s_lshr_b32 s40, s40, 2
    s_mul_i32 s42, s41, 3
    s_add_u32 s42, s42, s40
    s_mul_i32 s42, s42, 81920
    s_add_u32 s68, s42, s44
    s_mul_i32 s42, s41, 96
    s_add_u32 s42, s42, s40
    s_lshl_b32 s42, s42, 7
    s_add_u32 s69, s42, s45
    s_bfe_u32 s40, s36, 0x4000c
    s_and_b32 s41, s40, 3
    s_lshr_b32 s40, s40, 2
    s_mul_i32 s42, s41, 3
    s_add_u32 s42, s42, s40
    s_mul_i32 s42, s42, 81920
    s_add_u32 s70, s42, s44
    s_mul_i32 s42, s41, 96
    s_add_u32 s42, s42, s40
    s_lshl_b32 s42, s42, 7
    s_add_u32 s71, s42, s45
    s_bfe_u32 s40, s36, 0x40010
    s_and_b32 s41, s40, 3
    s_lshr_b32 s40, s40, 2
    s_mul_i32 s42, s41, 3
    s_add_u32 s42, s42, s40
    s_mul_i32 s42, s42, 81920
    s_add_u32 s72, s42, s44
    s_mul_i32 s42, s41, 96
    s_add_u32 s42, s42, s40
    s_lshl_b32 s42, s42, 7
    s_add_u32 s73, s42, s45
    s_bfe_u32 s40, s36, 0x40014
    s_and_b32 s41, s40, 3
    s_lshr_b32 s40, s40, 2
    s_mul_i32 s42, s41, 3
    s_add_u32 s42, s42, s40
    s_mul_i32 s42, s42, 81920
    s_add_u32 s74, s42, s44
    s_mul_i32 s42, s41, 96
    s_add_u32 s42, s42, s40
    s_lshl_b32 s42, s42, 7
    s_add_u32 s75, s42, s45
    s_bfe_u32 s40, s36, 0x40018
    s_and_b32 s41, s40, 3
    s_lshr_b32 s40, s40, 2
    s_mul_i32 s42, s41, 3
    s_add_u32 s42, s42, s40
    s_mul_i32 s42, s42, 81920
    s_add_u32 s76, s42, s44
    s_mul_i32 s42, s41, 96
    s_add_u32 s42, s42, s40
    s_lshl_b32 s42, s42, 7
    s_add_u32 s77, s42, s45
    s_bfe_u32 s40, s36, 0x4001c
    s_and_b32 s41, s40, 3
    s_lshr_b32 s40, s40, 2
    s_mul_i32 s42, s41, 3
    s_add_u32 s42, s42, s40
    s_mul_i32 s42, s42, 81920
    s_add_u32 s78, s42, s44
    s_mul_i32 s42, s41, 96
    s_add_u32 s42, s42, s40
    s_lshl_b32 s42, s42, 7
    s_add_u32 s79, s42, s45
    s_bfe_u32 s40, s37, 0x40000
    s_and_b32 s41, s40, 3
    s_lshr_b32 s40, s40, 2
    s_mul_i32 s42, s41, 3
    s_add_u32 s42, s42, s40
    s_mul_i32 s42, s42, 81920
    s_add_u32 s80, s42, s44
    s_mul_i32 s42, s41, 96
    s_add_u32 s42, s42, s40
    s_lshl_b32 s42, s42, 7
    s_add_u32 s81, s42, s45
    s_bfe_u32 s40, s37, 0x40004
    s_and_b32 s41, s40, 3
    s_lshr_b32 s40, s40, 2
    s_mul_i32 s42, s41, 3
    s_add_u32 s42, s42, s40
    s_mul_i32 s42, s42, 81920
    s_add_u32 s82, s42, s44
    s_mul_i32 s42, s41, 96
    s_add_u32 s42, s42, s40
    s_lshl_b32 s42, s42, 7
    s_add_u32 s83, s42, s45
    s_bfe_u32 s40, s37, 0x40008
    s_and_b32 s41, s40, 3
    s_lshr_b32 s40, s40, 2
    s_mul_i32 s42, s41, 3
    s_add_u32 s42, s42, s40
    s_mul_i32 s42, s42, 81920
    s_add_u32 s84, s42, s44
    s_mul_i32 s42, s41, 96
    s_add_u32 s42, s42, s40
    s_lshl_b32 s42, s42, 7
    s_add_u32 s85, s42, s45
    s_bfe_u32 s40, s37, 0x4000c
    s_and_b32 s41, s40, 3
    s_lshr_b32 s40, s40, 2
    s_mul_i32 s42, s41, 3
    s_add_u32 s42, s42, s40
    s_mul_i32 s42, s42, 81920
    s_add_u32 s86, s42, s44
    s_mul_i32 s42, s41, 96
    s_add_u32 s42, s42, s40
    s_lshl_b32 s42, s42, 7
    s_add_u32 s87, s42, s45
    s_mov_b64 exec, 0
    s_cmp_eq_u32 s32, 0
    s_cbranch_scc1 B_PG0
    s_cmp_eq_u32 s32, 1
    s_cbranch_scc1 B_PG1
    s_cmp_eq_u32 s32, 2
    s_cbranch_scc1 B_PG2
    s_cmp_eq_u32 s32, 3
    s_cbranch_scc1 B_PG3
B_PG3:
B_WARM_END:
    s_mov_b64 exec, -1
    buffer_load_dwordx4 v8, s[8:11], s66 offen lds
    buffer_load_dwordx4 v9, s[8:11], s66 offen offset:1024 lds
    s_add_u32 m0, s39, 40960
    s_nop 0
    buffer_load_dwordx4 v14, s[4:7], s67 offen lds
    buffer_load_dwordx4 v15, s[4:7], s67 offen offset:1024 lds
    s_add_u32 m0, s3, 43008
    s_nop 0
    buffer_load_dwordx4 v10, s[8:11], s66 offen lds
    s_add_u32 m0, s47, 40960
    s_nop 0
    buffer_load_dwordx4 v11, s[8:11], s66 offen lds
    buffer_load_dwordx4 v12, s[8:11], s66 offen offset:1024 lds
    s_add_u32 m0, s48, 40960
    s_nop 0
    buffer_load_dwordx4 v16, s[4:7], s67 offen lds
    buffer_load_dwordx4 v17, s[4:7], s67 offen offset:1024 lds
    s_add_u32 m0, s38, 81920
    s_waitcnt vmcnt(9)
    s_barrier
    ds_read_b64_tr_b16 a[224:225], v26 offset:0
    ds_read_b64_tr_b16 a[226:227], v26 offset:512
    ds_read_b128 a[160:163], v36 offset:0
    ds_read_b64_tr_b16 a[228:229], v26 offset:12288
    ds_read_b64_tr_b16 a[230:231], v26 offset:12800
    ds_read_b128 a[164:167], v37 offset:0
    ds_read_b128 a[168:171], v36 offset:2048
    ds_read_b128 a[172:175], v37 offset:2048
    ds_read_b128 a[176:179], v36 offset:8192
    ds_read_b128 a[180:183], v37 offset:8192
    ds_read_b128 a[184:187], v36 offset:10240
    ds_read_b128 a[188:191], v37 offset:10240
    s_waitcnt lgkmcnt(9)
    v_mfma_f32_16x16x32_bf16 v[96:99], a[160:163], a[224:227], 0
    ds_read_b64_tr_b16 a[232:233], v27 offset:0
    s_waitcnt lgkmcnt(7)
    v_mfma_f32_16x16x32_bf16 v[96:99], a[164:167], a[228:231], v[96:99]
    ds_read_b64_tr_b16 a[234:235], v27 offset:512
    s_waitcnt lgkmcnt(6)
    v_mfma_f32_16x16x32_bf16 v[100:103], a[172:175], a[228:231], 0
    ds_read_b64_tr_b16 a[236:237], v27 offset:12288
    v_mfma_f32_16x16x32_bf16 v[100:103], a[168:171], a[224:227], v[100:103]
    ds_read_b64_tr_b16 a[238:239], v27 offset:12800
    s_waitcnt lgkmcnt(7)
    v_mfma_f32_16x16x32_bf16 v[104:107], a[176:179], a[224:227], 0
    buffer_load_dwordx4 v8, s[8:11], s68 offen lds
    s_waitcnt lgkmcnt(3)
    v_mfma_f32_16x16x32_bf16 v[104:107], a[180:183], a[228:231], v[104:107]
    ds_read_b64_tr_b16 a[240:241], v28 offset:0
    v_mfma_f32_16x16x32_bf16 v[108:111], a[188:191], a[228:231], 0
    ds_read_b64_tr_b16 a[242:243], v28 offset:512
    v_mfma_f32_16x16x32_bf16 v[108:111], a[184:187], a[224:227], v[108:111]
    ds_read_b64_tr_b16 a[244:245], v28 offset:12288
    s_waitcnt lgkmcnt(3)
    v_mfma_f32_16x16x32_bf16 v[124:127], a[184:187], a[232:235], 0
    buffer_load_dwordx4 v9, s[8:11], s68 offen offset:1024 lds
    s_add_u32 m0, s39, 81920
    v_mfma_f32_16x16x32_bf16 v[124:127], a[188:191], a[236:239], v[124:127]
    ds_read_b64_tr_b16 a[246:247], v28 offset:12800
    v_mfma_f32_16x16x32_bf16 v[120:123], a[180:183], a[236:239], 0
    ds_read_b64_tr_b16 a[248:249], v29 offset:0
    v_mfma_f32_16x16x32_bf16 v[120:123], a[176:179], a[232:235], v[120:123]
    ds_read_b64_tr_b16 a[250:251], v29 offset:512
    v_mfma_f32_16x16x32_bf16 v[116:119], a[168:171], a[232:235], 0
    buffer_load_dwordx4 v14, s[4:7], s69 offen lds
    v_mfma_f32_16x16x32_bf16 v[116:119], a[172:175], a[236:239], v[116:119]
    ds_read_b64_tr_b16 a[252:253], v29 offset:12288
    v_mfma_f32_16x16x32_bf16 v[112:115], a[164:167], a[236:239], 0
    ds_read_b64_tr_b16 a[254:255], v29 offset:12800
    v_mfma_f32_16x16x32_bf16 v[112:115], a[160:163], a[232:235], v[112:115]
    ds_read_b64_tr_b16 v[40:41], v30 offset:0
    s_waitcnt lgkmcnt(3)
    v_mfma_f32_16x16x32_bf16 v[128:131], a[160:163], a[240:243], 0
    buffer_load_dwordx4 v15, s[4:7], s69 offen offset:1024 lds
    s_add_u32 m0, s3, 83968
    v_mfma_f32_16x16x32_bf16 v[128:131], a[164:167], a[244:247], v[128:131]
    ds_read_b64_tr_b16 v[42:43], v30 offset:256
    v_mfma_f32_16x16x32_bf16 v[132:135], a[172:175], a[244:247], 0
    ds_read_b64_tr_b16 v[44:45], v30 offset:12288
    v_mfma_f32_16x16x32_bf16 v[132:135], a[168:171], a[240:243], v[132:135]
    ds_read_b64_tr_b16 v[46:47], v30 offset:12544
    v_mfma_f32_16x16x32_bf16 v[136:139], a[176:179], a[240:243], 0
    buffer_load_dwordx4 v10, s[8:11], s68 offen lds
    s_add_u32 m0, s47, 81920
    v_mfma_f32_16x16x32_bf16 v[136:139], a[180:183], a[244:247], v[136:139]
    buffer_load_dwordx4 v11, s[8:11], s68 offen lds
    v_mfma_f32_16x16x32_bf16 v[140:143], a[188:191], a[244:247], 0
    v_mfma_f32_16x16x32_bf16 v[140:143], a[184:187], a[240:243], v[140:143]
    s_waitcnt vmcnt(6) lgkmcnt(0)
    s_barrier
    v_mfma_f32_16x16x32_bf16 v[156:159], a[184:187], a[248:251], 0
    ds_read_b64_tr_b16 a[224:225], v26 offset:40960
    v_mfma_f32_16x16x32_bf16 v[156:159], a[188:191], a[252:255], v[156:159]
    ds_read_b64_tr_b16 a[226:227], v26 offset:41472
    v_mfma_f32_16x16x32_bf16 v[152:155], a[180:183], a[252:255], 0
    ds_read_b128 a[192:195], v36 offset:40960
    v_mfma_f32_16x16x32_bf16 v[152:155], a[176:179], a[248:251], v[152:155]
    ds_read_b64_tr_b16 a[228:229], v26 offset:53248
    v_mfma_f32_16x16x32_bf16 v[148:151], a[168:171], a[248:251], 0
    ds_read_b64_tr_b16 a[230:231], v26 offset:53760
    v_mfma_f32_16x16x32_bf16 v[148:151], a[172:175], a[252:255], v[148:151]
    ds_read_b128 a[196:199], v37 offset:40960
    v_mfma_f32_16x16x32_bf16 v[144:147], a[164:167], a[252:255], 0
    buffer_load_dwordx4 v12, s[8:11], s68 offen offset:1024 lds
    s_add_u32 m0, s48, 81920
    v_mfma_f32_16x16x32_bf16 v[144:147], a[160:163], a[248:251], v[144:147]
    ds_read_b128 a[200:203], v36 offset:43008
    v_mfma_f32_16x16x32_bf16 v[160:163], a[160:163], v[40:43], 0
    ds_read_b128 a[204:207], v37 offset:43008
    v_mfma_f32_16x16x32_bf16 v[160:163], a[164:167], v[44:47], v[160:163]
    ds_read_b128 a[208:211], v36 offset:49152
    v_mfma_f32_16x16x32_bf16 v[164:167], a[172:175], v[44:47], 0
    ds_read_b128 a[212:215], v37 offset:49152
    v_mfma_f32_16x16x32_bf16 v[164:167], a[168:171], v[40:43], v[164:167]
    ds_read_b128 a[216:219], v36 offset:51200
    buffer_load_dwordx4 v16, s[4:7], s69 offen lds
    v_mfma_f32_16x16x32_bf16 v[168:171], a[176:179], v[40:43], 0
    ds_read_b128 a[220:223], v37 offset:51200
    v_mfma_f32_16x16x32_bf16 v[168:171], a[180:183], v[44:47], v[168:171]
    buffer_load_dwordx4 v17, s[4:7], s69 offen offset:1024 lds
    s_add_u32 m0, s38, 122880
    v_mfma_f32_16x16x32_bf16 v[172:175], a[188:191], v[44:47], 0
    buffer_load_dwordx4 v8, s[8:11], s70 offen lds
    v_mfma_f32_16x16x32_bf16 v[172:175], a[184:187], v[40:43], v[172:175]
    s_waitcnt lgkmcnt(1)
    v_mfma_f32_16x16x32_bf16 a[0:3], a[192:195], a[224:227], 0
    ds_read_b64_tr_b16 a[232:233], v27 offset:40960
    v_mfma_f32_16x16x32_bf16 a[0:3], a[196:199], a[228:231], a[0:3]
    ds_read_b64_tr_b16 a[234:235], v27 offset:41472
    v_mfma_f32_16x16x32_bf16 a[4:7], a[204:207], a[228:231], 0
    ds_read_b64_tr_b16 a[236:237], v27 offset:53248
    v_mfma_f32_16x16x32_bf16 a[4:7], a[200:203], a[224:227], a[4:7]
    ds_read_b64_tr_b16 a[238:239], v27 offset:53760
    v_mfma_f32_16x16x32_bf16 a[8:11], a[208:211], a[224:227], 0
    buffer_load_dwordx4 v9, s[8:11], s70 offen offset:1024 lds
    s_add_u32 m0, s39, 122880
    v_mfma_f32_16x16x32_bf16 a[8:11], a[212:215], a[228:231], a[8:11]
    ds_read_b64_tr_b16 a[240:241], v28 offset:40960
    s_waitcnt lgkmcnt(3)
    v_mfma_f32_16x16x32_bf16 a[12:15], a[220:223], a[228:231], 0
    ds_read_b64_tr_b16 a[242:243], v28 offset:41472
    v_mfma_f32_16x16x32_bf16 a[12:15], a[216:219], a[224:227], a[12:15]
    ds_read_b64_tr_b16 a[244:245], v28 offset:53248
    v_mfma_f32_16x16x32_bf16 a[28:31], a[216:219], a[232:235], 0
    buffer_load_dwordx4 v14, s[4:7], s71 offen lds
    s_waitcnt lgkmcnt(3)
    v_mfma_f32_16x16x32_bf16 a[28:31], a[220:223], a[236:239], a[28:31]
    ds_read_b64_tr_b16 a[246:247], v28 offset:53760
    v_mfma_f32_16x16x32_bf16 a[24:27], a[212:215], a[236:239], 0
    ds_read_b64_tr_b16 a[248:249], v29 offset:40960
    v_mfma_f32_16x16x32_bf16 a[24:27], a[208:211], a[232:235], a[24:27]
    ds_read_b64_tr_b16 a[250:251], v29 offset:41472
    v_mfma_f32_16x16x32_bf16 a[20:23], a[200:203], a[232:235], 0
    buffer_load_dwordx4 v15, s[4:7], s71 offen offset:1024 lds
    s_add_u32 m0, s3, 124928
    v_mfma_f32_16x16x32_bf16 a[20:23], a[204:207], a[236:239], a[20:23]
    ds_read_b64_tr_b16 a[252:253], v29 offset:53248
    v_mfma_f32_16x16x32_bf16 a[16:19], a[196:199], a[236:239], 0
    ds_read_b64_tr_b16 a[254:255], v29 offset:53760
    v_mfma_f32_16x16x32_bf16 a[16:19], a[192:195], a[232:235], a[16:19]
    ds_read_b64_tr_b16 v[40:41], v30 offset:40960
    s_waitcnt lgkmcnt(3)
    v_mfma_f32_16x16x32_bf16 a[32:35], a[192:195], a[240:243], 0
    buffer_load_dwordx4 v10, s[8:11], s70 offen lds
    s_add_u32 m0, s47, 122880
    v_mfma_f32_16x16x32_bf16 a[32:35], a[196:199], a[244:247], a[32:35]
    ds_read_b64_tr_b16 v[42:43], v30 offset:41216
    v_mfma_f32_16x16x32_bf16 a[36:39], a[204:207], a[244:247], 0
    ds_read_b64_tr_b16 v[44:45], v30 offset:53248
    v_mfma_f32_16x16x32_bf16 a[36:39], a[200:203], a[240:243], a[36:39]
    ds_read_b64_tr_b16 v[46:47], v30 offset:53504
    v_mfma_f32_16x16x32_bf16 a[40:43], a[208:211], a[240:243], 0
    buffer_load_dwordx4 v11, s[8:11], s70 offen lds
    v_mfma_f32_16x16x32_bf16 a[40:43], a[212:215], a[244:247], a[40:43]
    buffer_load_dwordx4 v12, s[8:11], s70 offen offset:1024 lds
    s_add_u32 m0, s48, 122880
    v_mfma_f32_16x16x32_bf16 a[44:47], a[220:223], a[244:247], 0
    v_mfma_f32_16x16x32_bf16 a[44:47], a[216:219], a[240:243], a[44:47]
    s_waitcnt vmcnt(7) lgkmcnt(0)
    s_barrier
    v_mfma_f32_16x16x32_bf16 a[60:63], a[216:219], a[248:251], 0
    ds_read_b64_tr_b16 a[224:225], v31 offset:0
    v_mfma_f32_16x16x32_bf16 a[60:63], a[220:223], a[252:255], a[60:63]
    ds_read_b64_tr_b16 a[226:227], v31 offset:512
    v_mfma_f32_16x16x32_bf16 a[56:59], a[212:215], a[252:255], 0
    ds_read_b128 a[160:163], v38 offset:0
    v_mfma_f32_16x16x32_bf16 a[56:59], a[208:211], a[248:251], a[56:59]
    ds_read_b64_tr_b16 a[228:229], v31 offset:12288
    v_mfma_f32_16x16x32_bf16 a[52:55], a[200:203], a[248:251], 0
    ds_read_b64_tr_b16 a[230:231], v31 offset:12800
    v_mfma_f32_16x16x32_bf16 a[52:55], a[204:207], a[252:255], a[52:55]
    ds_read_b128 a[164:167], v39 offset:0
    v_mfma_f32_16x16x32_bf16 a[48:51], a[196:199], a[252:255], 0
    buffer_load_dwordx4 v16, s[4:7], s71 offen lds
    v_mfma_f32_16x16x32_bf16 a[48:51], a[192:195], a[248:251], a[48:51]
    ds_read_b128 a[168:171], v38 offset:2048
    v_mfma_f32_16x16x32_bf16 a[64:67], a[192:195], v[40:43], 0
    ds_read_b128 a[172:175], v39 offset:2048
    v_mfma_f32_16x16x32_bf16 a[64:67], a[196:199], v[44:47], a[64:67]
    ds_read_b128 a[176:179], v38 offset:8192
    v_mfma_f32_16x16x32_bf16 a[68:71], a[204:207], v[44:47], 0
    ds_read_b128 a[180:183], v39 offset:8192
    v_mfma_f32_16x16x32_bf16 a[68:71], a[200:203], v[40:43], a[68:71]
    ds_read_b128 a[184:187], v38 offset:10240
    buffer_load_dwordx4 v17, s[4:7], s71 offen offset:1024 lds
    s_add_u32 m0, s38, 0
    v_mfma_f32_16x16x32_bf16 a[72:75], a[208:211], v[40:43], 0
    ds_read_b128 a[188:191], v39 offset:10240
    v_mfma_f32_16x16x32_bf16 a[72:75], a[212:215], v[44:47], a[72:75]
    buffer_load_dwordx4 v8, s[8:11], s72 offen lds
    v_mfma_f32_16x16x32_bf16 a[76:79], a[220:223], v[44:47], 0
    buffer_load_dwordx4 v9, s[8:11], s72 offen offset:1024 lds
    s_add_u32 m0, s39, 0
    v_mfma_f32_16x16x32_bf16 a[76:79], a[216:219], v[40:43], a[76:79]
    s_waitcnt lgkmcnt(1)
    v_mfma_f32_16x16x32_bf16 a[80:83], a[160:163], a[224:227], 0
    ds_read_b64_tr_b16 a[232:233], v32 offset:0
    v_mfma_f32_16x16x32_bf16 a[80:83], a[164:167], a[228:231], a[80:83]
    ds_read_b64_tr_b16 a[234:235], v32 offset:512
    v_mfma_f32_16x16x32_bf16 a[84:87], a[172:175], a[228:231], 0
    ds_read_b64_tr_b16 a[236:237], v32 offset:12288
    v_mfma_f32_16x16x32_bf16 a[84:87], a[168:171], a[224:227], a[84:87]
    ds_read_b64_tr_b16 a[238:239], v32 offset:12800
    v_mfma_f32_16x16x32_bf16 a[88:91], a[176:179], a[224:227], 0
    buffer_load_dwordx4 v14, s[4:7], s73 offen lds
    v_mfma_f32_16x16x32_bf16 a[88:91], a[180:183], a[228:231], a[88:91]
    ds_read_b64_tr_b16 a[240:241], v33 offset:0
    s_waitcnt lgkmcnt(3)
    v_mfma_f32_16x16x32_bf16 a[92:95], a[188:191], a[228:231], 0
    ds_read_b64_tr_b16 a[242:243], v33 offset:512
    v_mfma_f32_16x16x32_bf16 a[92:95], a[184:187], a[224:227], a[92:95]
    ds_read_b64_tr_b16 a[244:245], v33 offset:12288
    v_mfma_f32_16x16x32_bf16 a[108:111], a[184:187], a[232:235], 0
    buffer_load_dwordx4 v15, s[4:7], s73 offen offset:1024 lds
    s_add_u32 m0, s3, 2048
    s_waitcnt lgkmcnt(3)
    v_mfma_f32_16x16x32_bf16 a[108:111], a[188:191], a[236:239], a[108:111]
    ds_read_b64_tr_b16 a[246:247], v33 offset:12800
    v_mfma_f32_16x16x32_bf16 a[104:107], a[180:183], a[236:239], 0
    ds_read_b64_tr_b16 a[248:249], v34 offset:0
    v_mfma_f32_16x16x32_bf16 a[104:107], a[176:179], a[232:235], a[104:107]
    ds_read_b64_tr_b16 a[250:251], v34 offset:512
    v_mfma_f32_16x16x32_bf16 a[100:103], a[168:171], a[232:235], 0
    buffer_load_dwordx4 v10, s[8:11], s72 offen lds
    s_add_u32 m0, s47, 0
    v_mfma_f32_16x16x32_bf16 a[100:103], a[172:175], a[236:239], a[100:103]
    ds_read_b64_tr_b16 a[252:253], v34 offset:12288
    v_mfma_f32_16x16x32_bf16 a[96:99], a[164:167], a[236:239], 0
    ds_read_b64_tr_b16 a[254:255], v34 offset:12800
    v_mfma_f32_16x16x32_bf16 a[96:99], a[160:163], a[232:235], a[96:99]
    ds_read_b64_tr_b16 v[40:41], v35 offset:0
    s_waitcnt lgkmcnt(3)
    v_mfma_f32_16x16x32_bf16 a[112:115], a[160:163], a[240:243], 0
    buffer_load_dwordx4 v11, s[8:11], s72 offen lds
    v_mfma_f32_16x16x32_bf16 a[112:115], a[164:167], a[244:247], a[112:115]
    ds_read_b64_tr_b16 v[42:43], v35 offset:256
    v_mfma_f32_16x16x32_bf16 a[116:119], a[172:175], a[244:247], 0
    ds_read_b64_tr_b16 v[44:45], v35 offset:12288
    v_mfma_f32_16x16x32_bf16 a[116:119], a[168:171], a[240:243], a[116:119]
    ds_read_b64_tr_b16 v[46:47], v35 offset:12544
    v_mfma_f32_16x16x32_bf16 a[120:123], a[176:179], a[240:243], 0
    buffer_load_dwordx4 v12, s[8:11], s72 offen offset:1024 lds
    s_add_u32 m0, s48, 0
    v_mfma_f32_16x16x32_bf16 a[120:123], a[180:183], a[244:247], a[120:123]
    buffer_load_dwordx4 v16, s[4:7], s73 offen lds
    v_mfma_f32_16x16x32_bf16 a[124:127], a[188:191], a[244:247], 0
    v_mfma_f32_16x16x32_bf16 a[124:127], a[184:187], a[240:243], a[124:127]
    s_waitcnt vmcnt(8) lgkmcnt(0)
    s_barrier
    v_mfma_f32_16x16x32_bf16 a[140:143], a[184:187], a[248:251], 0
    ds_read_b64_tr_b16 a[224:225], v31 offset:40960
    v_mfma_f32_16x16x32_bf16 a[140:143], a[188:191], a[252:255], a[140:143]
    ds_read_b64_tr_b16 a[226:227], v31 offset:41472
    v_mfma_f32_16x16x32_bf16 a[136:139], a[180:183], a[252:255], 0
    ds_read_b128 a[192:195], v38 offset:40960
    v_mfma_f32_16x16x32_bf16 a[136:139], a[176:179], a[248:251], a[136:139]
    ds_read_b64_tr_b16 a[228:229], v31 offset:53248
    v_mfma_f32_16x16x32_bf16 a[132:135], a[168:171], a[248:251], 0
    ds_read_b64_tr_b16 a[230:231], v31 offset:53760
    v_mfma_f32_16x16x32_bf16 a[132:135], a[172:175], a[252:255], a[132:135]
    ds_read_b128 a[196:199], v39 offset:40960
    v_mfma_f32_16x16x32_bf16 a[128:131], a[164:167], a[252:255], 0
    buffer_load_dwordx4 v17, s[4:7], s73 offen offset:1024 lds
    s_add_u32 m0, s38, 40960
    v_mfma_f32_16x16x32_bf16 a[128:131], a[160:163], a[248:251], a[128:131]
    ds_read_b128 a[200:203], v38 offset:43008
    v_mfma_f32_16x16x32_bf16 a[144:147], a[160:163], v[40:43], 0
    ds_read_b128 a[204:207], v39 offset:43008
    v_mfma_f32_16x16x32_bf16 a[144:147], a[164:167], v[44:47], a[144:147]
    ds_read_b128 a[208:211], v38 offset:49152
    v_mfma_f32_16x16x32_bf16 a[148:151], a[172:175], v[44:47], 0
    ds_read_b128 a[212:215], v39 offset:49152
    v_mfma_f32_16x16x32_bf16 a[148:151], a[168:171], v[40:43], a[148:151]
    ds_read_b128 a[216:219], v38 offset:51200
    buffer_load_dwordx4 v8, s[8:11], s74 offen lds
    v_mfma_f32_16x16x32_bf16 a[152:155], a[176:179], v[40:43], 0
    ds_read_b128 a[220:223], v39 offset:51200
    v_mfma_f32_16x16x32_bf16 a[152:155], a[180:183], v[44:47], a[152:155]
    buffer_load_dwordx4 v9, s[8:11], s74 offen offset:1024 lds
    s_add_u32 m0, s39, 40960
    v_mfma_f32_16x16x32_bf16 a[156:159], a[188:191], v[44:47], 0
    buffer_load_dwordx4 v14, s[4:7], s75 offen lds
    v_mfma_f32_16x16x32_bf16 a[156:159], a[184:187], v[40:43], a[156:159]
    s_waitcnt lgkmcnt(1)
    v_mfma_f32_16x16x32_bf16 v[176:179], a[192:195], a[224:227], 0
    ds_read_b64_tr_b16 a[232:233], v32 offset:40960
    v_mfma_f32_16x16x32_bf16 v[176:179], a[196:199], a[228:231], v[176:179]
    ds_read_b64_tr_b16 a[234:235], v32 offset:41472
    v_mfma_f32_16x16x32_bf16 v[180:183], a[204:207], a[228:231], 0
    ds_read_b64_tr_b16 a[236:237], v32 offset:53248
    v_mfma_f32_16x16x32_bf16 v[180:183], a[200:203], a[224:227], v[180:183]
    ds_read_b64_tr_b16 a[238:239], v32 offset:53760
    v_mfma_f32_16x16x32_bf16 v[184:187], a[208:211], a[224:227], 0
    buffer_load_dwordx4 v15, s[4:7], s75 offen offset:1024 lds
    s_add_u32 m0, s3, 43008
    v_mfma_f32_16x16x32_bf16 v[184:187], a[212:215], a[228:231], v[184:187]
    ds_read_b64_tr_b16 a[240:241], v33 offset:40960
    s_waitcnt lgkmcnt(3)
    v_mfma_f32_16x16x32_bf16 v[188:191], a[220:223], a[228:231], 0
    ds_read_b64_tr_b16 a[242:243], v33 offset:41472
    v_mfma_f32_16x16x32_bf16 v[188:191], a[216:219], a[224:227], v[188:191]
    ds_read_b64_tr_b16 a[244:245], v33 offset:53248
    v_mfma_f32_16x16x32_bf16 v[204:207], a[216:219], a[232:235], 0
    buffer_load_dwordx4 v10, s[8:11], s74 offen lds
    s_add_u32 m0, s47, 40960
    s_waitcnt lgkmcnt(3)
    v_mfma_f32_16x16x32_bf16 v[204:207], a[220:223], a[236:239], v[204:207]
    ds_read_b64_tr_b16 a[246:247], v33 offset:53760
    v_mfma_f32_16x16x32_bf16 v[200:203], a[212:215], a[236:239], 0
    ds_read_b64_tr_b16 a[248:249], v34 offset:40960
    v_mfma_f32_16x16x32_bf16 v[200:203], a[208:211], a[232:235], v[200:203]
    ds_read_b64_tr_b16 a[250:251], v34 offset:41472
    v_mfma_f32_16x16x32_bf16 v[196:199], a[200:203], a[232:235], 0
    buffer_load_dwordx4 v11, s[8:11], s74 offen lds
    v_mfma_f32_16x16x32_bf16 v[196:199], a[204:207], a[236:239], v[196:199]
    ds_read_b64_tr_b16 a[252:253], v34 offset:53248
    v_mfma_f32_16x16x32_bf16 v[192:195], a[196:199], a[236:239], 0
    ds_read_b64_tr_b16 a[254:255], v34 offset:53760
    v_mfma_f32_16x16x32_bf16 v[192:195], a[192:195], a[232:235], v[192:195]
    ds_read_b64_tr_b16 v[40:41], v35 offset:40960
    s_waitcnt lgkmcnt(3)
    v_mfma_f32_16x16x32_bf16 v[208:211], a[192:195], a[240:243], 0
    buffer_load_dwordx4 v12, s[8:11], s74 offen offset:1024 lds
    s_add_u32 m0, s48, 40960
    v_mfma_f32_16x16x32_bf16 v[208:211], a[196:199], a[244:247], v[208:211]
    ds_read_b64_tr_b16 v[42:43], v35 offset:41216
    v_mfma_f32_16x16x32_bf16 v[212:215], a[204:207], a[244:247], 0
    ds_read_b64_tr_b16 v[44:45], v35 offset:53248
    v_mfma_f32_16x16x32_bf16 v[212:215], a[200:203], a[240:243], v[212:215]
    ds_read_b64_tr_b16 v[46:47], v35 offset:53504
    v_mfma_f32_16x16x32_bf16 v[216:219], a[208:211], a[240:243], 0
    buffer_load_dwordx4 v16, s[4:7], s75 offen lds
B_PG0:
    s_cbranch_execz B_WARM_END
    v_mfma_f32_16x16x32_bf16 v[216:219], a[212:215], a[244:247], v[216:219]
    buffer_load_dwordx4 v17, s[4:7], s75 offen offset:1024 lds
    s_add_u32 m0, s38, 81920
    v_mfma_f32_16x16x32_bf16 v[220:223], a[220:223], a[244:247], 0
    v_mfma_f32_16x16x32_bf16 v[220:223], a[216:219], a[240:243], v[220:223]
    s_waitcnt vmcnt(9) lgkmcnt(0)
    s_barrier
    v_mfma_f32_16x16x32_bf16 v[236:239], a[216:219], a[248:251], 0
    ds_read_b64_tr_b16 a[224:225], v26 offset:0
    v_mfma_f32_16x16x32_bf16 v[236:239], a[220:223], a[252:255], v[236:239]
    ds_read_b64_tr_b16 a[226:227], v26 offset:512
    v_mfma_f32_16x16x32_bf16 v[232:235], a[212:215], a[252:255], 0
    ds_read_b128 a[160:163], v36 offset:0
    v_mfma_f32_16x16x32_bf16 v[232:235], a[208:211], a[248:251], v[232:235]
    ds_read_b64_tr_b16 a[228:229], v26 offset:12288
    v_mfma_f32_16x16x32_bf16 v[228:231], a[200:203], a[248:251], 0
    ds_read_b64_tr_b16 a[230:231], v26 offset:12800
    v_mfma_f32_16x16x32_bf16 v[228:231], a[204:207], a[252:255], v[228:231]
    ds_read_b128 a[164:167], v37 offset:0
    v_mfma_f32_16x16x32_bf16 v[224:227], a[196:199], a[252:255], 0
    buffer_load_dwordx4 v8, s[8:11], s76 offen lds
    v_mfma_f32_16x16x32_bf16 v[224:227], a[192:195], a[248:251], v[224:227]
    ds_read_b128 a[168:171], v36 offset:2048
    v_mfma_f32_16x16x32_bf16 v[240:243], a[192:195], v[40:43], 0
    ds_read_b128 a[172:175], v37 offset:2048
    v_mfma_f32_16x16x32_bf16 v[240:243], a[196:199], v[44:47], v[240:243]
    ds_read_b128 a[176:179], v36 offset:8192
    v_mfma_f32_16x16x32_bf16 v[244:247], a[204:207], v[44:47], 0
    ds_read_b128 a[180:183], v37 offset:8192
    v_mfma_f32_16x16x32_bf16 v[244:247], a[200:203], v[40:43], v[244:247]
    ds_read_b128 a[184:187], v36 offset:10240
    buffer_load_dwordx4 v9, s[8:11], s76 offen offset:1024 lds
    s_add_u32 m0, s39, 81920
    v_mfma_f32_16x16x32_bf16 v[248:251], a[208:211], v[40:43], 0
    ds_read_b128 a[188:191], v37 offset:10240
    v_mfma_f32_16x16x32_bf16 v[248:251], a[212:215], v[44:47], v[248:251]
    buffer_load_dwordx4 v14, s[4:7], s77 offen lds
    v_mfma_f32_16x16x32_bf16 v[252:255], a[220:223], v[44:47], 0
    buffer_load_dwordx4 v15, s[4:7], s77 offen offset:1024 lds
    s_add_u32 m0, s3, 83968
    v_mfma_f32_16x16x32_bf16 v[252:255], a[216:219], v[40:43], v[252:255]
    s_waitcnt lgkmcnt(1)
    v_mfma_f32_16x16x32_bf16 v[96:99], a[160:163], a[224:227], v[96:99]
    ds_read_b64_tr_b16 a[232:233], v27 offset:0
    v_mfma_f32_16x16x32_bf16 v[96:99], a[164:167], a[228:231], v[96:99]
    ds_read_b64_tr_b16 a[234:235], v27 offset:512
    v_mfma_f32_16x16x32_bf16 v[100:103], a[172:175], a[228:231], v[100:103]
    ds_read_b64_tr_b16 a[236:237], v27 offset:12288
    v_mfma_f32_16x16x32_bf16 v[100:103], a[168:171], a[224:227], v[100:103]
    ds_read_b64_tr_b16 a[238:239], v27 offset:12800
    v_mfma_f32_16x16x32_bf16 v[104:107], a[176:179], a[224:227], v[104:107]
    buffer_load_dwordx4 v10, s[8:11], s76 offen lds
    s_add_u32 m0, s47, 81920
    v_mfma_f32_16x16x32_bf16 v[104:107], a[180:183], a[228:231], v[104:107]
    ds_read_b64_tr_b16 a[240:241], v28 offset:0
    s_waitcnt lgkmcnt(3)
    v_mfma_f32_16x16x32_bf16 v[108:111], a[188:191], a[228:231], v[108:111]
    ds_read_b64_tr_b16 a[242:243], v28 offset:512
    v_mfma_f32_16x16x32_bf16 v[108:111], a[184:187], a[224:227], v[108:111]
    ds_read_b64_tr_b16 a[244:245], v28 offset:12288
    v_mfma_f32_16x16x32_bf16 v[124:127], a[184:187], a[232:235], v[124:127]
    buffer_load_dwordx4 v11, s[8:11], s76 offen lds
    s_waitcnt lgkmcnt(3)
    v_mfma_f32_16x16x32_bf16 v[124:127], a[188:191], a[236:239], v[124:127]
    ds_read_b64_tr_b16 a[246:247], v28 offset:12800
    v_mfma_f32_16x16x32_bf16 v[120:123], a[180:183], a[236:239], v[120:123]
    ds_read_b64_tr_b16 a[248:249], v29 offset:0
    v_mfma_f32_16x16x32_bf16 v[120:123], a[176:179], a[232:235], v[120:123]
    ds_read_b64_tr_b16 a[250:251], v29 offset:512
    v_mfma_f32_16x16x32_bf16 v[116:119], a[168:171], a[232:235], v[116:119]
    buffer_load_dwordx4 v12, s[8:11], s76 offen offset:1024 lds
    s_add_u32 m0, s48, 81920
    v_mfma_f32_16x16x32_bf16 v[116:119], a[172:175], a[236:239], v[116:119]
    ds_read_b64_tr_b16 a[252:253], v29 offset:12288
    v_mfma_f32_16x16x32_bf16 v[112:115], a[164:167], a[236:239], v[112:115]
    ds_read_b64_tr_b16 a[254:255], v29 offset:12800
    v_mfma_f32_16x16x32_bf16 v[112:115], a[160:163], a[232:235], v[112:115]
    ds_read_b64_tr_b16 v[40:41], v30 offset:0
    s_waitcnt lgkmcnt(3)
    v_mfma_f32_16x16x32_bf16 v[128:131], a[160:163], a[240:243], v[128:131]
    buffer_load_dwordx4 v16, s[4:7], s77 offen lds
    v_mfma_f32_16x16x32_bf16 v[128:131], a[164:167], a[244:247], v[128:131]
    ds_read_b64_tr_b16 v[42:43], v30 offset:256
    v_mfma_f32_16x16x32_bf16 v[132:135], a[172:175], a[244:247], v[132:135]
    ds_read_b64_tr_b16 v[44:45], v30 offset:12288
    v_mfma_f32_16x16x32_bf16 v[132:135], a[168:171], a[240:243], v[132:135]
    ds_read_b64_tr_b16 v[46:47], v30 offset:12544
    v_mfma_f32_16x16x32_bf16 v[136:139], a[176:179], a[240:243], v[136:139]
    buffer_load_dwordx4 v17, s[4:7], s77 offen offset:1024 lds
    s_add_u32 m0, s38, 122880
    v_mfma_f32_16x16x32_bf16 v[136:139], a[180:183], a[244:247], v[136:139]
    buffer_load_dwordx4 v8, s[8:11], s78 offen lds
    v_mfma_f32_16x16x32_bf16 v[140:143], a[188:191], a[244:247], v[140:143]
    v_mfma_f32_16x16x32_bf16 v[140:143], a[184:187], a[240:243], v[140:143]
    s_waitcnt vmcnt(10) lgkmcnt(0)
    s_barrier
    v_mfma_f32_16x16x32_bf16 v[156:159], a[184:187], a[248:251], v[156:159]
    ds_read_b64_tr_b16 a[224:225], v26 offset:40960
    v_mfma_f32_16x16x32_bf16 v[156:159], a[188:191], a[252:255], v[156:159]
    ds_read_b64_tr_b16 a[226:227], v26 offset:41472
    v_mfma_f32_16x16x32_bf16 v[152:155], a[180:183], a[252:255], v[152:155]
    ds_read_b128 a[192:195], v36 offset:40960
    v_mfma_f32_16x16x32_bf16 v[152:155], a[176:179], a[248:251], v[152:155]
    ds_read_b64_tr_b16 a[228:229], v26 offset:53248
    v_mfma_f32_16x16x32_bf16 v[148:151], a[168:171], a[248:251], v[148:151]
    ds_read_b64_tr_b16 a[230:231], v26 offset:53760
    v_mfma_f32_16x16x32_bf16 v[148:151], a[172:175], a[252:255], v[148:151]
    ds_read_b128 a[196:199], v37 offset:40960
    v_mfma_f32_16x16x32_bf16 v[144:147], a[164:167], a[252:255], v[144:147]
    buffer_load_dwordx4 v9, s[8:11], s78 offen offset:1024 lds
    s_add_u32 m0, s39, 122880
    v_mfma_f32_16x16x32_bf16 v[144:147], a[160:163], a[248:251], v[144:147]
    ds_read_b128 a[200:203], v36 offset:43008
    v_mfma_f32_16x16x32_bf16 v[160:163], a[160:163], v[40:43], v[160:163]
    ds_read_b128 a[204:207], v37 offset:43008
    v_mfma_f32_16x16x32_bf16 v[160:163], a[164:167], v[44:47], v[160:163]
    ds_read_b128 a[208:211], v36 offset:49152
    v_mfma_f32_16x16x32_bf16 v[164:167], a[172:175], v[44:47], v[164:167]
    ds_read_b128 a[212:215], v37 offset:49152
    v_mfma_f32_16x16x32_bf16 v[164:167], a[168:171], v[40:43], v[164:167]
    ds_read_b128 a[216:219], v36 offset:51200
    buffer_load_dwordx4 v14, s[4:7], s79 offen lds
    v_mfma_f32_16x16x32_bf16 v[168:171], a[176:179], v[40:43], v[168:171]
    ds_read_b128 a[220:223], v37 offset:51200
    v_mfma_f32_16x16x32_bf16 v[168:171], a[180:183], v[44:47], v[168:171]
    buffer_load_dwordx4 v15, s[4:7], s79 offen offset:1024 lds
    s_add_u32 m0, s3, 124928
    v_mfma_f32_16x16x32_bf16 v[172:175], a[188:191], v[44:47], v[172:175]
    buffer_load_dwordx4 v10, s[8:11], s78 offen lds
    s_add_u32 m0, s47, 122880
    v_mfma_f32_16x16x32_bf16 v[172:175], a[184:187], v[40:43], v[172:175]
    s_waitcnt lgkmcnt(1)
    v_mfma_f32_16x16x32_bf16 a[0:3], a[192:195], a[224:227], a[0:3]
    ds_read_b64_tr_b16 a[232:233], v27 offset:40960
    v_mfma_f32_16x16x32_bf16 a[0:3], a[196:199], a[228:231], a[0:3]
    ds_read_b64_tr_b16 a[234:235], v27 offset:41472
    v_mfma_f32_16x16x32_bf16 a[4:7], a[204:207], a[228:231], a[4:7]
    ds_read_b64_tr_b16 a[236:237], v27 offset:53248
    v_mfma_f32_16x16x32_bf16 a[4:7], a[200:203], a[224:227], a[4:7]
    ds_read_b64_tr_b16 a[238:239], v27 offset:53760
    v_mfma_f32_16x16x32_bf16 a[8:11], a[208:211], a[224:227], a[8:11]
    buffer_load_dwordx4 v11, s[8:11], s78 offen lds
    v_mfma_f32_16x16x32_bf16 a[8:11], a[212:215], a[228:231], a[8:11]
    ds_read_b64_tr_b16 a[240:241], v28 offset:40960
    s_waitcnt lgkmcnt(3)
    v_mfma_f32_16x16x32_bf16 a[12:15], a[220:223], a[228:231], a[12:15]
    ds_read_b64_tr_b16 a[242:243], v28 offset:41472
    v_mfma_f32_16x16x32_bf16 a[12:15], a[216:219], a[224:227], a[12:15]
    ds_read_b64_tr_b16 a[244:245], v28 offset:53248
    v_mfma_f32_16x16x32_bf16 a[28:31], a[216:219], a[232:235], a[28:31]
    buffer_load_dwordx4 v12, s[8:11], s78 offen offset:1024 lds
    s_add_u32 m0, s48, 122880
    s_waitcnt lgkmcnt(3)
    v_mfma_f32_16x16x32_bf16 a[28:31], a[220:223], a[236:239], a[28:31]
    ds_read_b64_tr_b16 a[246:247], v28 offset:53760
    v_mfma_f32_16x16x32_bf16 a[24:27], a[212:215], a[236:239], a[24:27]
    ds_read_b64_tr_b16 a[248:249], v29 offset:40960
    v_mfma_f32_16x16x32_bf16 a[24:27], a[208:211], a[232:235], a[24:27]
    ds_read_b64_tr_b16 a[250:251], v29 offset:41472
    v_mfma_f32_16x16x32_bf16 a[20:23], a[200:203], a[232:235], a[20:23]
    buffer_load_dwordx4 v16, s[4:7], s79 offen lds
    v_mfma_f32_16x16x32_bf16 a[20:23], a[204:207], a[236:239], a[20:23]
    ds_read_b64_tr_b16 a[252:253], v29 offset:53248
    v_mfma_f32_16x16x32_bf16 a[16:19], a[196:199], a[236:239], a[16:19]
    ds_read_b64_tr_b16 a[254:255], v29 offset:53760
    v_mfma_f32_16x16x32_bf16 a[16:19], a[192:195], a[232:235], a[16:19]
    ds_read_b64_tr_b16 v[40:41], v30 offset:40960
    s_waitcnt lgkmcnt(3)
    v_mfma_f32_16x16x32_bf16 a[32:35], a[192:195], a[240:243], a[32:35]
    buffer_load_dwordx4 v17, s[4:7], s79 offen offset:1024 lds
    s_add_u32 m0, s38, 0
    v_mfma_f32_16x16x32_bf16 a[32:35], a[196:199], a[244:247], a[32:35]
    ds_read_b64_tr_b16 v[42:43], v30 offset:41216
    v_mfma_f32_16x16x32_bf16 a[36:39], a[204:207], a[244:247], a[36:39]
    ds_read_b64_tr_b16 v[44:45], v30 offset:53248
    v_mfma_f32_16x16x32_bf16 a[36:39], a[200:203], a[240:243], a[36:39]
    ds_read_b64_tr_b16 v[46:47], v30 offset:53504
    v_mfma_f32_16x16x32_bf16 a[40:43], a[208:211], a[240:243], a[40:43]
    buffer_load_dwordx4 v8, s[8:11], s80 offen lds
    v_mfma_f32_16x16x32_bf16 a[40:43], a[212:215], a[244:247], a[40:43]
    buffer_load_dwordx4 v9, s[8:11], s80 offen offset:1024 lds
    s_add_u32 m0, s39, 0
    v_mfma_f32_16x16x32_bf16 a[44:47], a[220:223], a[244:247], a[44:47]
    v_mfma_f32_16x16x32_bf16 a[44:47], a[216:219], a[240:243], a[44:47]
    s_waitcnt vmcnt(11) lgkmcnt(0)
    s_barrier
    v_mfma_f32_16x16x32_bf16 a[60:63], a[216:219], a[248:251], a[60:63]
    ds_read_b64_tr_b16 a[224:225], v31 offset:0
    v_mfma_f32_16x16x32_bf16 a[60:63], a[220:223], a[252:255], a[60:63]
    ds_read_b64_tr_b16 a[226:227], v31 offset:512
    v_mfma_f32_16x16x32_bf16 a[56:59], a[212:215], a[252:255], a[56:59]
    ds_read_b128 a[160:163], v38 offset:0
    v_mfma_f32_16x16x32_bf16 a[56:59], a[208:211], a[248:251], a[56:59]
    ds_read_b64_tr_b16 a[228:229], v31 offset:12288
    v_mfma_f32_16x16x32_bf16 a[52:55], a[200:203], a[248:251], a[52:55]
    ds_read_b64_tr_b16 a[230:231], v31 offset:12800
    v_mfma_f32_16x16x32_bf16 a[52:55], a[204:207], a[252:255], a[52:55]
    ds_read_b128 a[164:167], v39 offset:0
    v_mfma_f32_16x16x32_bf16 a[48:51], a[196:199], a[252:255], a[48:51]
    buffer_load_dwordx4 v14, s[4:7], s81 offen lds
    v_mfma_f32_16x16x32_bf16 a[48:51], a[192:195], a[248:251], a[48:51]
    ds_read_b128 a[168:171], v38 offset:2048
    v_mfma_f32_16x16x32_bf16 a[64:67], a[192:195], v[40:43], a[64:67]
    ds_read_b128 a[172:175], v39 offset:2048
    v_mfma_f32_16x16x32_bf16 a[64:67], a[196:199], v[44:47], a[64:67]
    ds_read_b128 a[176:179], v38 offset:8192
    v_mfma_f32_16x16x32_bf16 a[68:71], a[204:207], v[44:47], a[68:71]
    ds_read_b128 a[180:183], v39 offset:8192
    v_mfma_f32_16x16x32_bf16 a[68:71], a[200:203], v[40:43], a[68:71]
    ds_read_b128 a[184:187], v38 offset:10240
    buffer_load_dwordx4 v15, s[4:7], s81 offen offset:1024 lds
    s_add_u32 m0, s3, 2048
    v_mfma_f32_16x16x32_bf16 a[72:75], a[208:211], v[40:43], a[72:75]
    ds_read_b128 a[188:191], v39 offset:10240
    v_mfma_f32_16x16x32_bf16 a[72:75], a[212:215], v[44:47], a[72:75]
    buffer_load_dwordx4 v10, s[8:11], s80 offen lds
    s_add_u32 m0, s47, 0
    v_mfma_f32_16x16x32_bf16 a[76:79], a[220:223], v[44:47], a[76:79]
    buffer_load_dwordx4 v11, s[8:11], s80 offen lds
    v_mfma_f32_16x16x32_bf16 a[76:79], a[216:219], v[40:43], a[76:79]
    s_waitcnt lgkmcnt(1)
    v_mfma_f32_16x16x32_bf16 a[80:83], a[160:163], a[224:227], a[80:83]
    ds_read_b64_tr_b16 a[232:233], v32 offset:0
    v_mfma_f32_16x16x32_bf16 a[80:83], a[164:167], a[228:231], a[80:83]
    ds_read_b64_tr_b16 a[234:235], v32 offset:512
    v_mfma_f32_16x16x32_bf16 a[84:87], a[172:175], a[228:231], a[84:87]
    ds_read_b64_tr_b16 a[236:237], v32 offset:12288
    v_mfma_f32_16x16x32_bf16 a[84:87], a[168:171], a[224:227], a[84:87]
    ds_read_b64_tr_b16 a[238:239], v32 offset:12800
    v_mfma_f32_16x16x32_bf16 a[88:91], a[176:179], a[224:227], a[88:91]
    buffer_load_dwordx4 v12, s[8:11], s80 offen offset:1024 lds
    s_add_u32 m0, s48, 0
    v_mfma_f32_16x16x32_bf16 a[88:91], a[180:183], a[228:231], a[88:91]
    ds_read_b64_tr_b16 a[240:241], v33 offset:0
    s_waitcnt lgkmcnt(3)
    v_mfma_f32_16x16x32_bf16 a[92:95], a[188:191], a[228:231], a[92:95]
    ds_read_b64_tr_b16 a[242:243], v33 offset:512
    v_mfma_f32_16x16x32_bf16 a[92:95], a[184:187], a[224:227], a[92:95]
    ds_read_b64_tr_b16 a[244:245], v33 offset:12288
    v_mfma_f32_16x16x32_bf16 a[108:111], a[184:187], a[232:235], a[108:111]
    buffer_load_dwordx4 v16, s[4:7], s81 offen lds
    s_waitcnt lgkmcnt(3)
    v_mfma_f32_16x16x32_bf16 a[108:111], a[188:191], a[236:239], a[108:111]
    ds_read_b64_tr_b16 a[246:247], v33 offset:12800
    v_mfma_f32_16x16x32_bf16 a[104:107], a[180:183], a[236:239], a[104:107]
    ds_read_b64_tr_b16 a[248:249], v34 offset:0
    v_mfma_f32_16x16x32_bf16 a[104:107], a[176:179], a[232:235], a[104:107]
    ds_read_b64_tr_b16 a[250:251], v34 offset:512
    v_mfma_f32_16x16x32_bf16 a[100:103], a[168:171], a[232:235], a[100:103]
    buffer_load_dwordx4 v17, s[4:7], s81 offen offset:1024 lds
    s_add_u32 m0, s38, 40960
    v_mfma_f32_16x16x32_bf16 a[100:103], a[172:175], a[236:239], a[100:103]
    ds_read_b64_tr_b16 a[252:253], v34 offset:12288
    v_mfma_f32_16x16x32_bf16 a[96:99], a[164:167], a[236:239], a[96:99]
    ds_read_b64_tr_b16 a[254:255], v34 offset:12800
    v_mfma_f32_16x16x32_bf16 a[96:99], a[160:163], a[232:235], a[96:99]
    ds_read_b64_tr_b16 v[40:41], v35 offset:0
    s_waitcnt lgkmcnt(3)
    v_mfma_f32_16x16x32_bf16 a[112:115], a[160:163], a[240:243], a[112:115]
    buffer_load_dwordx4 v8, s[8:11], s82 offen lds
    v_mfma_f32_16x16x32_bf16 a[112:115], a[164:167], a[244:247], a[112:115]
    ds_read_b64_tr_b16 v[42:43], v35 offset:256
    v_mfma_f32_16x16x32_bf16 a[116:119], a[172:175], a[244:247], a[116:119]
    ds_read_b64_tr_b16 v[44:45], v35 offset:12288
    v_mfma_f32_16x16x32_bf16 a[116:119], a[168:171], a[240:243], a[116:119]
    ds_read_b64_tr_b16 v[46:47], v35 offset:12544
    v_mfma_f32_16x16x32_bf16 a[120:123], a[176:179], a[240:243], a[120:123]
    buffer_load_dwordx4 v9, s[8:11], s82 offen offset:1024 lds
    s_add_u32 m0, s39, 40960
    v_mfma_f32_16x16x32_bf16 a[120:123], a[180:183], a[244:247], a[120:123]
    buffer_load_dwordx4 v14, s[4:7], s83 offen lds
    v_mfma_f32_16x16x32_bf16 a[124:127], a[188:191], a[244:247], a[124:127]
    v_mfma_f32_16x16x32_bf16 a[124:127], a[184:187], a[240:243], a[124:127]
    s_waitcnt vmcnt(12) lgkmcnt(0)
    s_barrier
    v_mfma_f32_16x16x32_bf16 a[140:143], a[184:187], a[248:251], a[140:143]
    ds_read_b64_tr_b16 a[224:225], v31 offset:40960
    v_mfma_f32_16x16x32_bf16 a[140:143], a[188:191], a[252:255], a[140:143]
    ds_read_b64_tr_b16 a[226:227], v31 offset:41472
    v_mfma_f32_16x16x32_bf16 a[136:139], a[180:183], a[252:255], a[136:139]
    ds_read_b128 a[192:195], v38 offset:40960
    v_mfma_f32_16x16x32_bf16 a[136:139], a[176:179], a[248:251], a[136:139]
    ds_read_b64_tr_b16 a[228:229], v31 offset:53248
    v_mfma_f32_16x16x32_bf16 a[132:135], a[168:171], a[248:251], a[132:135]
    ds_read_b64_tr_b16 a[230:231], v31 offset:53760
    v_mfma_f32_16x16x32_bf16 a[132:135], a[172:175], a[252:255], a[132:135]
    ds_read_b128 a[196:199], v39 offset:40960
    v_mfma_f32_16x16x32_bf16 a[128:131], a[164:167], a[252:255], a[128:131]
    buffer_load_dwordx4 v15, s[4:7], s83 offen offset:1024 lds
    s_add_u32 m0, s3, 43008
    v_mfma_f32_16x16x32_bf16 a[128:131], a[160:163], a[248:251], a[128:131]
    ds_read_b128 a[200:203], v38 offset:43008
    v_mfma_f32_16x16x32_bf16 a[144:147], a[160:163], v[40:43], a[144:147]
    ds_read_b128 a[204:207], v39 offset:43008
    v_mfma_f32_16x16x32_bf16 a[144:147], a[164:167], v[44:47], a[144:147]
    ds_read_b128 a[208:211], v38 offset:49152
    v_mfma_f32_16x16x32_bf16 a[148:151], a[172:175], v[44:47], a[148:151]
    ds_read_b128 a[212:215], v39 offset:49152
    v_mfma_f32_16x16x32_bf16 a[148:151], a[168:171], v[40:43], a[148:151]
    ds_read_b128 a[216:219], v38 offset:51200
    buffer_load_dwordx4 v10, s[8:11], s82 offen lds
    s_add_u32 m0, s47, 40960
    v_mfma_f32_16x16x32_bf16 a[152:155], a[176:179], v[40:43], a[152:155]
    ds_read_b128 a[220:223], v39 offset:51200
    v_mfma_f32_16x16x32_bf16 a[152:155], a[180:183], v[44:47], a[152:155]
    buffer_load_dwordx4 v11, s[8:11], s82 offen lds
    v_mfma_f32_16x16x32_bf16 a[156:159], a[188:191], v[44:47], a[156:159]
    buffer_load_dwordx4 v12, s[8:11], s82 offen offset:1024 lds
    s_add_u32 m0, s48, 40960
    v_mfma_f32_16x16x32_bf16 a[156:159], a[184:187], v[40:43], a[156:159]
    s_waitcnt lgkmcnt(1)
    v_mfma_f32_16x16x32_bf16 v[176:179], a[192:195], a[224:227], v[176:179]
    ds_read_b64_tr_b16 a[232:233], v32 offset:40960
    v_mfma_f32_16x16x32_bf16 v[176:179], a[196:199], a[228:231], v[176:179]
    ds_read_b64_tr_b16 a[234:235], v32 offset:41472
    v_mfma_f32_16x16x32_bf16 v[180:183], a[204:207], a[228:231], v[180:183]
    ds_read_b64_tr_b16 a[236:237], v32 offset:53248
    v_mfma_f32_16x16x32_bf16 v[180:183], a[200:203], a[224:227], v[180:183]
    ds_read_b64_tr_b16 a[238:239], v32 offset:53760
    v_mfma_f32_16x16x32_bf16 v[184:187], a[208:211], a[224:227], v[184:187]
    buffer_load_dwordx4 v16, s[4:7], s83 offen lds
    v_mfma_f32_16x16x32_bf16 v[184:187], a[212:215], a[228:231], v[184:187]
    ds_read_b64_tr_b16 a[240:241], v33 offset:40960
    s_waitcnt lgkmcnt(3)
    v_mfma_f32_16x16x32_bf16 v[188:191], a[220:223], a[228:231], v[188:191]
    ds_read_b64_tr_b16 a[242:243], v33 offset:41472
    v_mfma_f32_16x16x32_bf16 v[188:191], a[216:219], a[224:227], v[188:191]
    ds_read_b64_tr_b16 a[244:245], v33 offset:53248
    v_mfma_f32_16x16x32_bf16 v[204:207], a[216:219], a[232:235], v[204:207]
    buffer_load_dwordx4 v17, s[4:7], s83 offen offset:1024 lds
    s_add_u32 m0, s38, 81920
    s_waitcnt lgkmcnt(3)
    v_mfma_f32_16x16x32_bf16 v[204:207], a[220:223], a[236:239], v[204:207]
    ds_read_b64_tr_b16 a[246:247], v33 offset:53760
    v_mfma_f32_16x16x32_bf16 v[200:203], a[212:215], a[236:239], v[200:203]
    ds_read_b64_tr_b16 a[248:249], v34 offset:40960
    v_mfma_f32_16x16x32_bf16 v[200:203], a[208:211], a[232:235], v[200:203]
    ds_read_b64_tr_b16 a[250:251], v34 offset:41472
    v_mfma_f32_16x16x32_bf16 v[196:199], a[200:203], a[232:235], v[196:199]
    buffer_load_dwordx4 v8, s[8:11], s84 offen lds
    v_mfma_f32_16x16x32_bf16 v[196:199], a[204:207], a[236:239], v[196:199]
    ds_read_b64_tr_b16 a[252:253], v34 offset:53248
    v_mfma_f32_16x16x32_bf16 v[192:195], a[196:199], a[236:239], v[192:195]
    ds_read_b64_tr_b16 a[254:255], v34 offset:53760
    v_mfma_f32_16x16x32_bf16 v[192:195], a[192:195], a[232:235], v[192:195]
    ds_read_b64_tr_b16 v[40:41], v35 offset:40960
    s_waitcnt lgkmcnt(3)
    v_mfma_f32_16x16x32_bf16 v[208:211], a[192:195], a[240:243], v[208:211]
    buffer_load_dwordx4 v9, s[8:11], s84 offen offset:1024 lds
    s_add_u32 m0, s39, 81920
    v_mfma_f32_16x16x32_bf16 v[208:211], a[196:199], a[244:247], v[208:211]
    ds_read_b64_tr_b16 v[42:43], v35 offset:41216
    v_mfma_f32_16x16x32_bf16 v[212:215], a[204:207], a[244:247], v[212:215]
    ds_read_b64_tr_b16 v[44:45], v35 offset:53248
    v_mfma_f32_16x16x32_bf16 v[212:215], a[200:203], a[240:243], v[212:215]
    ds_read_b64_tr_b16 v[46:47], v35 offset:53504
    v_mfma_f32_16x16x32_bf16 v[216:219], a[208:211], a[240:243], v[216:219]
    buffer_load_dwordx4 v14, s[4:7], s85 offen lds
    v_mfma_f32_16x16x32_bf16 v[216:219], a[212:215], a[244:247], v[216:219]
    buffer_load_dwordx4 v15, s[4:7], s85 offen offset:1024 lds
    s_add_u32 m0, s3, 83968
    v_mfma_f32_16x16x32_bf16 v[220:223], a[220:223], a[244:247], v[220:223]
    v_mfma_f32_16x16x32_bf16 v[220:223], a[216:219], a[240:243], v[220:223]
    s_waitcnt vmcnt(13) lgkmcnt(0)
    s_barrier
    v_mfma_f32_16x16x32_bf16 v[236:239], a[216:219], a[248:251], v[236:239]
    ds_read_b64_tr_b16 a[224:225], v26 offset:0
    v_mfma_f32_16x16x32_bf16 v[236:239], a[220:223], a[252:255], v[236:239]
    ds_read_b64_tr_b16 a[226:227], v26 offset:512
    v_mfma_f32_16x16x32_bf16 v[232:235], a[212:215], a[252:255], v[232:235]
    ds_read_b128 a[160:163], v36 offset:0
    v_mfma_f32_16x16x32_bf16 v[232:235], a[208:211], a[248:251], v[232:235]
    ds_read_b64_tr_b16 a[228:229], v26 offset:12288
    v_mfma_f32_16x16x32_bf16 v[228:231], a[200:203], a[248:251], v[228:231]
    ds_read_b64_tr_b16 a[230:231], v26 offset:12800
    v_mfma_f32_16x16x32_bf16 v[228:231], a[204:207], a[252:255], v[228:231]
    ds_read_b128 a[164:167], v37 offset:0
    v_mfma_f32_16x16x32_bf16 v[224:227], a[196:199], a[252:255], v[224:227]
    buffer_load_dwordx4 v10, s[8:11], s84 offen lds
    s_add_u32 m0, s47, 81920
    v_mfma_f32_16x16x32_bf16 v[224:227], a[192:195], a[248:251], v[224:227]
    ds_read_b128 a[168:171], v36 offset:2048
    v_mfma_f32_16x16x32_bf16 v[240:243], a[192:195], v[40:43], v[240:243]
    ds_read_b128 a[172:175], v37 offset:2048
    v_mfma_f32_16x16x32_bf16 v[240:243], a[196:199], v[44:47], v[240:243]
    ds_read_b128 a[176:179], v36 offset:8192
    v_mfma_f32_16x16x32_bf16 v[244:247], a[204:207], v[44:47], v[244:247]
    ds_read_b128 a[180:183], v37 offset:8192
    v_mfma_f32_16x16x32_bf16 v[244:247], a[200:203], v[40:43], v[244:247]
    ds_read_b128 a[184:187], v36 offset:10240
    buffer_load_dwordx4 v11, s[8:11], s84 offen lds
    v_mfma_f32_16x16x32_bf16 v[248:251], a[208:211], v[40:43], v[248:251]
    ds_read_b128 a[188:191], v37 offset:10240
    v_mfma_f32_16x16x32_bf16 v[248:251], a[212:215], v[44:47], v[248:251]
    buffer_load_dwordx4 v12, s[8:11], s84 offen offset:1024 lds
    s_add_u32 m0, s48, 81920
    v_mfma_f32_16x16x32_bf16 v[252:255], a[220:223], v[44:47], v[252:255]
    buffer_load_dwordx4 v16, s[4:7], s85 offen lds
    v_mfma_f32_16x16x32_bf16 v[252:255], a[216:219], v[40:43], v[252:255]
    s_waitcnt lgkmcnt(1)
    v_mfma_f32_16x16x32_bf16 v[96:99], a[160:163], a[224:227], v[96:99]
    ds_read_b64_tr_b16 a[232:233], v27 offset:0
    v_mfma_f32_16x16x32_bf16 v[96:99], a[164:167], a[228:231], v[96:99]
    ds_read_b64_tr_b16 a[234:235], v27 offset:512
    v_mfma_f32_16x16x32_bf16 v[100:103], a[172:175], a[228:231], v[100:103]
    ds_read_b64_tr_b16 a[236:237], v27 offset:12288
    v_mfma_f32_16x16x32_bf16 v[100:103], a[168:171], a[224:227], v[100:103]
    ds_read_b64_tr_b16 a[238:239], v27 offset:12800
    v_mfma_f32_16x16x32_bf16 v[104:107], a[176:179], a[224:227], v[104:107]
    buffer_load_dwordx4 v17, s[4:7], s85 offen offset:1024 lds
    s_add_u32 m0, s38, 122880
    v_mfma_f32_16x16x32_bf16 v[104:107], a[180:183], a[228:231], v[104:107]
    ds_read_b64_tr_b16 a[240:241], v28 offset:0
    s_waitcnt lgkmcnt(3)
    v_mfma_f32_16x16x32_bf16 v[108:111], a[188:191], a[228:231], v[108:111]
    ds_read_b64_tr_b16 a[242:243], v28 offset:512
    v_mfma_f32_16x16x32_bf16 v[108:111], a[184:187], a[224:227], v[108:111]
    ds_read_b64_tr_b16 a[244:245], v28 offset:12288
    v_mfma_f32_16x16x32_bf16 v[124:127], a[184:187], a[232:235], v[124:127]
    buffer_load_dwordx4 v8, s[8:11], s86 offen lds
    s_waitcnt lgkmcnt(3)
    v_mfma_f32_16x16x32_bf16 v[124:127], a[188:191], a[236:239], v[124:127]
    ds_read_b64_tr_b16 a[246:247], v28 offset:12800
    v_mfma_f32_16x16x32_bf16 v[120:123], a[180:183], a[236:239], v[120:123]
    ds_read_b64_tr_b16 a[248:249], v29 offset:0
    v_mfma_f32_16x16x32_bf16 v[120:123], a[176:179], a[232:235], v[120:123]
    ds_read_b64_tr_b16 a[250:251], v29 offset:512
    v_mfma_f32_16x16x32_bf16 v[116:119], a[168:171], a[232:235], v[116:119]
    buffer_load_dwordx4 v9, s[8:11], s86 offen offset:1024 lds
    s_add_u32 m0, s39, 122880
    v_mfma_f32_16x16x32_bf16 v[116:119], a[172:175], a[236:239], v[116:119]
    ds_read_b64_tr_b16 a[252:253], v29 offset:12288
    v_mfma_f32_16x16x32_bf16 v[112:115], a[164:167], a[236:239], v[112:115]
    ds_read_b64_tr_b16 a[254:255], v29 offset:12800
    v_mfma_f32_16x16x32_bf16 v[112:115], a[160:163], a[232:235], v[112:115]
    ds_read_b64_tr_b16 v[40:41], v30 offset:0
    s_waitcnt lgkmcnt(3)
    v_mfma_f32_16x16x32_bf16 v[128:131], a[160:163], a[240:243], v[128:131]
    v_cvt_pk_bf16_f32 v96, v96, v97
    v_cvt_pk_bf16_f32 v97, v98, v99
    v_mfma_f32_16x16x32_bf16 v[128:131], a[164:167], a[244:247], v[128:131]
    ds_read_b64_tr_b16 v[42:43], v30 offset:256
    v_cvt_pk_bf16_f32 v98, v100, v101
    v_mfma_f32_16x16x32_bf16 v[132:135], a[172:175], a[244:247], v[132:135]
    ds_read_b64_tr_b16 v[44:45], v30 offset:12288
    v_cvt_pk_bf16_f32 v99, v102, v103
    v_mfma_f32_16x16x32_bf16 v[132:135], a[168:171], a[240:243], v[132:135]
    ds_read_b64_tr_b16 v[46:47], v30 offset:12544
    v_cvt_pk_bf16_f32 v100, v104, v105
    buffer_load_dwordx4 v14, s[4:7], s87 offen lds
    v_mfma_f32_16x16x32_bf16 v[136:139], a[176:179], a[240:243], v[136:139]
    v_cvt_pk_bf16_f32 v101, v106, v107
    v_cvt_pk_bf16_f32 v102, v108, v109
    v_mfma_f32_16x16x32_bf16 v[136:139], a[180:183], a[244:247], v[136:139]
    v_cvt_pk_bf16_f32 v103, v110, v111
    v_mfma_f32_16x16x32_bf16 v[140:143], a[188:191], a[244:247], v[140:143]
    buffer_load_dwordx4 v15, s[4:7], s87 offen offset:1024 lds
    s_add_u32 m0, s3, 124928
    v_mfma_f32_16x16x32_bf16 v[140:143], a[184:187], a[240:243], v[140:143]
    s_waitcnt vmcnt(13) lgkmcnt(0)
    s_barrier
    v_mfma_f32_16x16x32_bf16 v[156:159], a[184:187], a[248:251], v[156:159]
    ds_read_b64_tr_b16 a[224:225], v26 offset:40960
    v_cvt_pk_bf16_f32 v104, v112, v113
    v_mfma_f32_16x16x32_bf16 v[156:159], a[188:191], a[252:255], v[156:159]
    ds_read_b64_tr_b16 a[226:227], v26 offset:41472
    v_cvt_pk_bf16_f32 v105, v114, v115
    v_mfma_f32_16x16x32_bf16 v[152:155], a[180:183], a[252:255], v[152:155]
    ds_read_b128 a[192:195], v36 offset:40960
    v_cvt_pk_bf16_f32 v106, v116, v117
    v_mfma_f32_16x16x32_bf16 v[152:155], a[176:179], a[248:251], v[152:155]
    ds_read_b64_tr_b16 a[228:229], v26 offset:53248
    v_cvt_pk_bf16_f32 v107, v118, v119
    buffer_load_dwordx4 v10, s[8:11], s86 offen lds
    s_add_u32 m0, s47, 122880
    v_mfma_f32_16x16x32_bf16 v[148:151], a[168:171], a[248:251], v[148:151]
    ds_read_b64_tr_b16 a[230:231], v26 offset:53760
    v_cvt_pk_bf16_f32 v108, v120, v121
    v_mfma_f32_16x16x32_bf16 v[148:151], a[172:175], a[252:255], v[148:151]
    ds_read_b128 a[196:199], v37 offset:40960
    v_cvt_pk_bf16_f32 v109, v122, v123
    v_mfma_f32_16x16x32_bf16 v[144:147], a[164:167], a[252:255], v[144:147]
    v_cvt_pk_bf16_f32 v110, v124, v125
    v_cvt_pk_bf16_f32 v111, v126, v127
    v_mfma_f32_16x16x32_bf16 v[144:147], a[160:163], a[248:251], v[144:147]
    ds_read_b128 a[200:203], v36 offset:43008
    buffer_load_dwordx4 v11, s[8:11], s86 offen lds
    v_mfma_f32_16x16x32_bf16 v[160:163], a[160:163], v[40:43], v[160:163]
    ds_read_b128 a[204:207], v37 offset:43008
    v_cvt_pk_bf16_f32 v112, v128, v129
    v_mfma_f32_16x16x32_bf16 v[160:163], a[164:167], v[44:47], v[160:163]
    ds_read_b128 a[208:211], v36 offset:49152
    v_cvt_pk_bf16_f32 v113, v130, v131
    v_mfma_f32_16x16x32_bf16 v[164:167], a[172:175], v[44:47], v[164:167]
    ds_read_b128 a[212:215], v37 offset:49152
    v_cvt_pk_bf16_f32 v114, v132, v133
    v_mfma_f32_16x16x32_bf16 v[164:167], a[168:171], v[40:43], v[164:167]
    ds_read_b128 a[216:219], v36 offset:51200
    v_cvt_pk_bf16_f32 v115, v134, v135
    buffer_load_dwordx4 v12, s[8:11], s86 offen offset:1024 lds
    s_add_u32 m0, s48, 122880
    v_mfma_f32_16x16x32_bf16 v[168:171], a[176:179], v[40:43], v[168:171]
    ds_read_b128 a[220:223], v37 offset:51200
    v_cvt_pk_bf16_f32 v116, v136, v137
    v_mfma_f32_16x16x32_bf16 v[168:171], a[180:183], v[44:47], v[168:171]
    v_cvt_pk_bf16_f32 v117, v138, v139
    v_cvt_pk_bf16_f32 v118, v140, v141
    v_mfma_f32_16x16x32_bf16 v[172:175], a[188:191], v[44:47], v[172:175]
    v_cvt_pk_bf16_f32 v119, v142, v143
    v_mfma_f32_16x16x32_bf16 v[172:175], a[184:187], v[40:43], v[172:175]
    s_load_dwordx2 s[88:89], s[24:25], 0
    buffer_load_dwordx4 v16, s[4:7], s87 offen lds
    s_waitcnt lgkmcnt(1)
    v_mfma_f32_16x16x32_bf16 a[0:3], a[192:195], a[224:227], a[0:3]
    ds_read_b64_tr_b16 a[232:233], v27 offset:40960
    v_cvt_pk_bf16_f32 v120, v144, v145
    v_mfma_f32_16x16x32_bf16 a[0:3], a[196:199], a[228:231], a[0:3]
    ds_read_b64_tr_b16 a[234:235], v27 offset:41472
    v_cvt_pk_bf16_f32 v121, v146, v147
    v_mfma_f32_16x16x32_bf16 a[4:7], a[204:207], a[228:231], a[4:7]
    ds_read_b64_tr_b16 a[236:237], v27 offset:53248
    v_cvt_pk_bf16_f32 v122, v148, v149
    v_mfma_f32_16x16x32_bf16 a[4:7], a[200:203], a[224:227], a[4:7]
    ds_read_b64_tr_b16 a[238:239], v27 offset:53760
    v_cvt_pk_bf16_f32 v123, v150, v151
    buffer_load_dwordx4 v17, s[4:7], s87 offen offset:1024 lds
    v_mfma_f32_16x16x32_bf16 a[8:11], a[208:211], a[224:227], a[8:11]
    v_cvt_pk_bf16_f32 v124, v152, v153
    v_cvt_pk_bf16_f32 v125, v154, v155
    v_mfma_f32_16x16x32_bf16 a[8:11], a[212:215], a[228:231], a[8:11]
B_PG1:
    s_cbranch_execz B_WARM_END
    ds_read_b64_tr_b16 a[240:241], v28 offset:40960
    v_cvt_pk_bf16_f32 v126, v156, v157
    s_waitcnt lgkmcnt(3)
    v_mfma_f32_16x16x32_bf16 a[12:15], a[220:223], a[228:231], a[12:15]
    ds_read_b64_tr_b16 a[242:243], v28 offset:41472
    v_cvt_pk_bf16_f32 v127, v158, v159
    v_mfma_f32_16x16x32_bf16 a[12:15], a[216:219], a[224:227], a[12:15]
    ds_read_b64_tr_b16 a[244:245], v28 offset:53248
    v_mfma_f32_16x16x32_bf16 a[28:31], a[216:219], a[232:235], a[28:31]
    v_cvt_pk_bf16_f32 v128, v160, v161
    v_cvt_pk_bf16_f32 v129, v162, v163
    s_waitcnt lgkmcnt(3)
    v_mfma_f32_16x16x32_bf16 a[28:31], a[220:223], a[236:239], a[28:31]
    ds_read_b64_tr_b16 a[246:247], v28 offset:53760
    v_cvt_pk_bf16_f32 v130, v164, v165
    v_mfma_f32_16x16x32_bf16 a[24:27], a[212:215], a[236:239], a[24:27]
    ds_read_b64_tr_b16 a[248:249], v29 offset:40960
    v_cvt_pk_bf16_f32 v131, v166, v167
    v_mfma_f32_16x16x32_bf16 a[24:27], a[208:211], a[232:235], a[24:27]
    ds_read_b64_tr_b16 a[250:251], v29 offset:41472
    v_cvt_pk_bf16_f32 v132, v168, v169
    v_mfma_f32_16x16x32_bf16 a[20:23], a[200:203], a[232:235], a[20:23]
    v_cvt_pk_bf16_f32 v133, v170, v171
    v_cvt_pk_bf16_f32 v134, v172, v173
    v_mfma_f32_16x16x32_bf16 a[20:23], a[204:207], a[236:239], a[20:23]
    ds_read_b64_tr_b16 a[252:253], v29 offset:53248
    v_cvt_pk_bf16_f32 v135, v174, v175
    v_mfma_f32_16x16x32_bf16 a[16:19], a[196:199], a[236:239], a[16:19]
    ds_read_b64_tr_b16 a[254:255], v29 offset:53760
    v_mfma_f32_16x16x32_bf16 a[16:19], a[192:195], a[232:235], a[16:19]
    ds_read_b64_tr_b16 v[40:41], v30 offset:40960
    s_waitcnt lgkmcnt(3)
    v_mfma_f32_16x16x32_bf16 a[32:35], a[192:195], a[240:243], a[32:35]
    v_accvgpr_read_b32 v88, a0
    v_accvgpr_read_b32 v89, a1
    v_mfma_f32_16x16x32_bf16 a[32:35], a[196:199], a[244:247], a[32:35]
    ds_read_b64_tr_b16 v[42:43], v30 offset:41216
    v_accvgpr_read_b32 v90, a2
    v_mfma_f32_16x16x32_bf16 a[36:39], a[204:207], a[244:247], a[36:39]
    ds_read_b64_tr_b16 v[44:45], v30 offset:53248
    v_accvgpr_read_b32 v91, a3
    v_mfma_f32_16x16x32_bf16 a[36:39], a[200:203], a[240:243], a[36:39]
    ds_read_b64_tr_b16 v[46:47], v30 offset:53504
    v_cvt_pk_bf16_f32 v48, v88, v89
    v_mfma_f32_16x16x32_bf16 a[40:43], a[208:211], a[240:243], a[40:43]
    v_cvt_pk_bf16_f32 v49, v90, v91
    v_accvgpr_read_b32 v92, a4
    v_mfma_f32_16x16x32_bf16 a[40:43], a[212:215], a[244:247], a[40:43]
    v_accvgpr_read_b32 v93, a5
    v_accvgpr_read_b32 v94, a6
    v_mfma_f32_16x16x32_bf16 a[44:47], a[220:223], a[244:247], a[44:47]
    v_accvgpr_read_b32 v95, a7
    v_cvt_pk_bf16_f32 v50, v92, v93
    v_mfma_f32_16x16x32_bf16 a[44:47], a[216:219], a[240:243], a[44:47]
    s_waitcnt vmcnt(9) lgkmcnt(0)
    s_barrier
    v_cvt_pk_bf16_f32 v51, v94, v95
    buffer_load_dwordx2 v[24:25], v4, s[16:19], s52 offen sc1
    v_mfma_f32_16x16x32_bf16 a[60:63], a[216:219], a[248:251], a[60:63]
    ds_read_b64_tr_b16 a[224:225], v31 offset:0
    v_accvgpr_read_b32 v88, a8
    v_mfma_f32_16x16x32_bf16 a[60:63], a[220:223], a[252:255], a[60:63]
    ds_read_b64_tr_b16 a[226:227], v31 offset:512
    v_accvgpr_read_b32 v89, a9
    v_mfma_f32_16x16x32_bf16 a[56:59], a[212:215], a[252:255], a[56:59]
    ds_read_b128 a[160:163], v38 offset:0
    v_accvgpr_read_b32 v90, a10
    v_mfma_f32_16x16x32_bf16 a[56:59], a[208:211], a[248:251], a[56:59]
    ds_read_b64_tr_b16 a[228:229], v31 offset:12288
    v_accvgpr_read_b32 v91, a11
    v_mfma_f32_16x16x32_bf16 a[52:55], a[200:203], a[248:251], a[52:55]
    ds_read_b64_tr_b16 a[230:231], v31 offset:12800
    v_cvt_pk_bf16_f32 v52, v88, v89
    v_mfma_f32_16x16x32_bf16 a[52:55], a[204:207], a[252:255], a[52:55]
    ds_read_b128 a[164:167], v39 offset:0
    v_cvt_pk_bf16_f32 v53, v90, v91
    v_mfma_f32_16x16x32_bf16 a[48:51], a[196:199], a[252:255], a[48:51]
    v_accvgpr_read_b32 v92, a12
    v_accvgpr_read_b32 v93, a13
    v_mfma_f32_16x16x32_bf16 a[48:51], a[192:195], a[248:251], a[48:51]
    ds_read_b128 a[168:171], v38 offset:2048
    v_accvgpr_read_b32 v94, a14
    v_mfma_f32_16x16x32_bf16 a[64:67], a[192:195], v[40:43], a[64:67]
    ds_read_b128 a[172:175], v39 offset:2048
    v_accvgpr_read_b32 v95, a15
    v_mfma_f32_16x16x32_bf16 a[64:67], a[196:199], v[44:47], a[64:67]
    ds_read_b128 a[176:179], v38 offset:8192
    v_cvt_pk_bf16_f32 v54, v92, v93
    v_mfma_f32_16x16x32_bf16 a[68:71], a[204:207], v[44:47], a[68:71]
    ds_read_b128 a[180:183], v39 offset:8192
    v_cvt_pk_bf16_f32 v55, v94, v95
    v_mfma_f32_16x16x32_bf16 a[68:71], a[200:203], v[40:43], a[68:71]
    ds_read_b128 a[184:187], v38 offset:10240
    v_accvgpr_read_b32 v88, a16
    v_mfma_f32_16x16x32_bf16 a[72:75], a[208:211], v[40:43], a[72:75]
    ds_read_b128 a[188:191], v39 offset:10240
    v_accvgpr_read_b32 v89, a17
    v_mfma_f32_16x16x32_bf16 a[72:75], a[212:215], v[44:47], a[72:75]
    v_accvgpr_read_b32 v90, a18
    v_accvgpr_read_b32 v91, a19
    v_mfma_f32_16x16x32_bf16 a[76:79], a[220:223], v[44:47], a[76:79]
    v_cvt_pk_bf16_f32 v56, v88, v89
    v_cvt_pk_bf16_f32 v57, v90, v91
    v_mfma_f32_16x16x32_bf16 a[76:79], a[216:219], v[40:43], a[76:79]
    v_mov_b32 v18, s88
    v_mov_b32 v19, s89
    s_cmp_eq_u32 s88, 0
    s_cbranch_scc1 B_NON_SLOW
B_NON_OK:
    v_accvgpr_read_b32 v92, a20
    s_waitcnt lgkmcnt(1)
    v_mfma_f32_16x16x32_bf16 a[80:83], a[160:163], a[224:227], a[80:83]
    ds_read_b64_tr_b16 a[232:233], v32 offset:0
    v_accvgpr_read_b32 v93, a21
    v_mfma_f32_16x16x32_bf16 a[80:83], a[164:167], a[228:231], a[80:83]
    ds_read_b64_tr_b16 a[234:235], v32 offset:512
    v_accvgpr_read_b32 v94, a22
    v_mfma_f32_16x16x32_bf16 a[84:87], a[172:175], a[228:231], a[84:87]
    ds_read_b64_tr_b16 a[236:237], v32 offset:12288
    v_accvgpr_read_b32 v95, a23
    v_mfma_f32_16x16x32_bf16 a[84:87], a[168:171], a[224:227], a[84:87]
    ds_read_b64_tr_b16 a[238:239], v32 offset:12800
    v_cvt_pk_bf16_f32 v58, v92, v93
    v_mfma_f32_16x16x32_bf16 a[88:91], a[176:179], a[224:227], a[88:91]
    v_cvt_pk_bf16_f32 v59, v94, v95
    v_accvgpr_read_b32 v88, a24
    v_mfma_f32_16x16x32_bf16 a[88:91], a[180:183], a[228:231], a[88:91]
    ds_read_b64_tr_b16 a[240:241], v33 offset:0
    v_accvgpr_read_b32 v89, a25
    s_waitcnt lgkmcnt(3)
    v_mfma_f32_16x16x32_bf16 a[92:95], a[188:191], a[228:231], a[92:95]
    ds_read_b64_tr_b16 a[242:243], v33 offset:512
    v_accvgpr_read_b32 v90, a26
    v_mfma_f32_16x16x32_bf16 a[92:95], a[184:187], a[224:227], a[92:95]
    ds_read_b64_tr_b16 a[244:245], v33 offset:12288
    v_accvgpr_read_b32 v91, a27
    v_mfma_f32_16x16x32_bf16 a[108:111], a[184:187], a[232:235], a[108:111]
    v_cvt_pk_bf16_f32 v60, v88, v89
    v_cvt_pk_bf16_f32 v61, v90, v91
    s_waitcnt lgkmcnt(3)
    v_mfma_f32_16x16x32_bf16 a[108:111], a[188:191], a[236:239], a[108:111]
    ds_read_b64_tr_b16 a[246:247], v33 offset:12800
    v_accvgpr_read_b32 v92, a28
    v_mfma_f32_16x16x32_bf16 a[104:107], a[180:183], a[236:239], a[104:107]
    ds_read_b64_tr_b16 a[248:249], v34 offset:0
    v_accvgpr_read_b32 v93, a29
    v_mfma_f32_16x16x32_bf16 a[104:107], a[176:179], a[232:235], a[104:107]
    ds_read_b64_tr_b16 a[250:251], v34 offset:512
    v_accvgpr_read_b32 v94, a30
    v_mfma_f32_16x16x32_bf16 a[100:103], a[168:171], a[232:235], a[100:103]
    v_accvgpr_read_b32 v95, a31
    v_cvt_pk_bf16_f32 v62, v92, v93
    v_mfma_f32_16x16x32_bf16 a[100:103], a[172:175], a[236:239], a[100:103]
    ds_read_b64_tr_b16 a[252:253], v34 offset:12288
    v_cvt_pk_bf16_f32 v63, v94, v95
    v_mfma_f32_16x16x32_bf16 a[96:99], a[164:167], a[236:239], a[96:99]
    ds_read_b64_tr_b16 a[254:255], v34 offset:12800
    v_accvgpr_read_b32 v88, a32
    v_mfma_f32_16x16x32_bf16 a[96:99], a[160:163], a[232:235], a[96:99]
    ds_read_b64_tr_b16 v[40:41], v35 offset:0
    v_accvgpr_read_b32 v89, a33
    s_waitcnt lgkmcnt(3)
    v_mfma_f32_16x16x32_bf16 a[112:115], a[160:163], a[240:243], a[112:115]
    v_accvgpr_read_b32 v90, a34
    v_accvgpr_read_b32 v91, a35
    v_mfma_f32_16x16x32_bf16 a[112:115], a[164:167], a[244:247], a[112:115]
    ds_read_b64_tr_b16 v[42:43], v35 offset:256
    v_cvt_pk_bf16_f32 v64, v88, v89
    v_mfma_f32_16x16x32_bf16 a[116:119], a[172:175], a[244:247], a[116:119]
    ds_read_b64_tr_b16 v[44:45], v35 offset:12288
    v_cvt_pk_bf16_f32 v65, v90, v91
    v_mfma_f32_16x16x32_bf16 a[116:119], a[168:171], a[240:243], a[116:119]
    ds_read_b64_tr_b16 v[46:47], v35 offset:12544
    v_accvgpr_read_b32 v92, a36
    v_mfma_f32_16x16x32_bf16 a[120:123], a[176:179], a[240:243], a[120:123]
    v_accvgpr_read_b32 v93, a37
    v_accvgpr_read_b32 v94, a38
    v_mfma_f32_16x16x32_bf16 a[120:123], a[180:183], a[244:247], a[120:123]
    v_accvgpr_read_b32 v95, a39
    v_cvt_pk_bf16_f32 v66, v92, v93
    v_mfma_f32_16x16x32_bf16 a[124:127], a[188:191], a[244:247], a[124:127]
    v_cvt_pk_bf16_f32 v67, v94, v95
    v_accvgpr_read_b32 v88, a40
    v_mfma_f32_16x16x32_bf16 a[124:127], a[184:187], a[240:243], a[124:127]
    s_waitcnt vmcnt(1) lgkmcnt(0)
    s_barrier
    v_accvgpr_read_b32 v89, a41
    v_mfma_f32_16x16x32_bf16 a[140:143], a[184:187], a[248:251], a[140:143]
    ds_read_b64_tr_b16 a[224:225], v31 offset:40960
    v_accvgpr_read_b32 v90, a42
    v_mfma_f32_16x16x32_bf16 a[140:143], a[188:191], a[252:255], a[140:143]
    ds_read_b64_tr_b16 a[226:227], v31 offset:41472
    v_accvgpr_read_b32 v91, a43
    v_mfma_f32_16x16x32_bf16 a[136:139], a[180:183], a[252:255], a[136:139]
    ds_read_b128 a[192:195], v38 offset:40960
    v_cvt_pk_bf16_f32 v68, v88, v89
    v_mfma_f32_16x16x32_bf16 a[136:139], a[176:179], a[248:251], a[136:139]
    ds_read_b64_tr_b16 a[228:229], v31 offset:53248
    v_cvt_pk_bf16_f32 v69, v90, v91
    v_mfma_f32_16x16x32_bf16 a[132:135], a[168:171], a[248:251], a[132:135]
    ds_read_b64_tr_b16 a[230:231], v31 offset:53760
    v_accvgpr_read_b32 v92, a44
    v_mfma_f32_16x16x32_bf16 a[132:135], a[172:175], a[252:255], a[132:135]
    ds_read_b128 a[196:199], v39 offset:40960
    v_accvgpr_read_b32 v93, a45
    v_mfma_f32_16x16x32_bf16 a[128:131], a[164:167], a[252:255], a[128:131]
    v_accvgpr_read_b32 v94, a46
    v_accvgpr_read_b32 v95, a47
    v_mfma_f32_16x16x32_bf16 a[128:131], a[160:163], a[248:251], a[128:131]
    ds_read_b128 a[200:203], v38 offset:43008
    v_cvt_pk_bf16_f32 v70, v92, v93
    v_mfma_f32_16x16x32_bf16 a[144:147], a[160:163], v[40:43], a[144:147]
    ds_read_b128 a[204:207], v39 offset:43008
    v_cvt_pk_bf16_f32 v71, v94, v95
    v_mfma_f32_16x16x32_bf16 a[144:147], a[164:167], v[44:47], a[144:147]
    ds_read_b128 a[208:211], v38 offset:49152
    v_accvgpr_read_b32 v88, a48
    v_mfma_f32_16x16x32_bf16 a[148:151], a[172:175], v[44:47], a[148:151]
    ds_read_b128 a[212:215], v39 offset:49152
    v_accvgpr_read_b32 v89, a49
    v_mfma_f32_16x16x32_bf16 a[148:151], a[168:171], v[40:43], a[148:151]
    ds_read_b128 a[216:219], v38 offset:51200
    v_accvgpr_read_b32 v90, a50
    v_mfma_f32_16x16x32_bf16 a[152:155], a[176:179], v[40:43], a[152:155]
    ds_read_b128 a[220:223], v39 offset:51200
    v_accvgpr_read_b32 v91, a51
    v_mfma_f32_16x16x32_bf16 a[152:155], a[180:183], v[44:47], a[152:155]
    v_cvt_pk_bf16_f32 v72, v88, v89
    v_cvt_pk_bf16_f32 v73, v90, v91
    v_mfma_f32_16x16x32_bf16 a[156:159], a[188:191], v[44:47], a[156:159]
    v_accvgpr_read_b32 v92, a52
    v_accvgpr_read_b32 v93, a53
    v_mfma_f32_16x16x32_bf16 a[156:159], a[184:187], v[40:43], a[156:159]
    v_accvgpr_read_b32 v94, a54
    v_accvgpr_read_b32 v95, a55
    s_waitcnt lgkmcnt(1)
    v_mfma_f32_16x16x32_bf16 v[176:179], a[192:195], a[224:227], v[176:179]
    ds_read_b64_tr_b16 a[232:233], v32 offset:40960
    v_cvt_pk_bf16_f32 v74, v92, v93
    v_mfma_f32_16x16x32_bf16 v[176:179], a[196:199], a[228:231], v[176:179]
    ds_read_b64_tr_b16 a[234:235], v32 offset:41472
    v_cvt_pk_bf16_f32 v75, v94, v95
    v_mfma_f32_16x16x32_bf16 v[180:183], a[204:207], a[228:231], v[180:183]
    ds_read_b64_tr_b16 a[236:237], v32 offset:53248
    v_accvgpr_read_b32 v88, a56
    v_mfma_f32_16x16x32_bf16 v[180:183], a[200:203], a[224:227], v[180:183]
    ds_read_b64_tr_b16 a[238:239], v32 offset:53760
    v_accvgpr_read_b32 v89, a57
    v_mfma_f32_16x16x32_bf16 v[184:187], a[208:211], a[224:227], v[184:187]
    v_accvgpr_read_b32 v90, a58
    v_accvgpr_read_b32 v91, a59
    v_mfma_f32_16x16x32_bf16 v[184:187], a[212:215], a[228:231], v[184:187]
    ds_read_b64_tr_b16 a[240:241], v33 offset:40960
    v_cvt_pk_bf16_f32 v76, v88, v89
    s_waitcnt lgkmcnt(3)
    v_mfma_f32_16x16x32_bf16 v[188:191], a[220:223], a[228:231], v[188:191]
    ds_read_b64_tr_b16 a[242:243], v33 offset:41472
    v_cvt_pk_bf16_f32 v77, v90, v91
    v_mfma_f32_16x16x32_bf16 v[188:191], a[216:219], a[224:227], v[188:191]
    ds_read_b64_tr_b16 a[244:245], v33 offset:53248
    v_accvgpr_read_b32 v92, a60
    v_mfma_f32_16x16x32_bf16 v[204:207], a[216:219], a[232:235], v[204:207]
    v_accvgpr_read_b32 v93, a61
    v_accvgpr_read_b32 v94, a62
    s_waitcnt lgkmcnt(3)
    v_mfma_f32_16x16x32_bf16 v[204:207], a[220:223], a[236:239], v[204:207]
    ds_read_b64_tr_b16 a[246:247], v33 offset:53760
    v_accvgpr_read_b32 v95, a63
    v_mfma_f32_16x16x32_bf16 v[200:203], a[212:215], a[236:239], v[200:203]
    ds_read_b64_tr_b16 a[248:249], v34 offset:40960
    v_cvt_pk_bf16_f32 v78, v92, v93
    v_mfma_f32_16x16x32_bf16 v[200:203], a[208:211], a[232:235], v[200:203]
    ds_read_b64_tr_b16 a[250:251], v34 offset:41472
    v_cvt_pk_bf16_f32 v79, v94, v95
    v_mfma_f32_16x16x32_bf16 v[196:199], a[200:203], a[232:235], v[196:199]
    v_accvgpr_read_b32 v88, a64
    v_accvgpr_read_b32 v89, a65
    v_mfma_f32_16x16x32_bf16 v[196:199], a[204:207], a[236:239], v[196:199]
    ds_read_b64_tr_b16 a[252:253], v34 offset:53248
    v_mov_b32 v10, v20
    v_mov_b32 v11, v2
    v_mov_b32 v8, 0
    v_mov_b32 v9, 0
    s_mov_b32 s43, 0
    s_mov_b32 s62, 31
    s_mov_b32 s41, 0
    s_waitcnt vmcnt(0)
B_CF:
    v_cmp_ne_u64 vcc, v[24:25], v[18:19]
    s_cbranch_vccnz B_CF_SLOW
    s_mov_b64 exec, 0xff
    buffer_load_dword v8, v5, s[16:19], s60 offen offset:1020 sc1
    s_mov_b64 exec, -1
    v_mfma_f32_16x16x32_bf16 v[192:195], a[196:199], a[236:239], v[192:195]
    ds_read_b64_tr_b16 a[254:255], v34 offset:53760
    buffer_load_dwordx4 a[160:163], v10, s[16:19], s53 offen sc1
    v_mfma_f32_16x16x32_bf16 v[192:195], a[192:195], a[232:235], v[192:195]
    ds_read_b64_tr_b16 v[40:41], v35 offset:40960
    v_accvgpr_read_b32 v90, a66
    s_waitcnt lgkmcnt(3)
    v_mfma_f32_16x16x32_bf16 v[208:211], a[192:195], a[240:243], v[208:211]
    buffer_load_dwordx4 a[164:167], v10, s[16:19], s53 offen offset:1024 sc1
    v_accvgpr_read_b32 v91, a67
    v_mfma_f32_16x16x32_bf16 v[208:211], a[196:199], a[244:247], v[208:211]
    ds_read_b64_tr_b16 v[42:43], v35 offset:41216
    v_cvt_pk_bf16_f32 v80, v88, v89
    v_mfma_f32_16x16x32_bf16 v[212:215], a[204:207], a[244:247], v[212:215]
    ds_read_b64_tr_b16 v[44:45], v35 offset:53248
    buffer_load_dwordx4 a[168:171], v10, s[16:19], s54 offen sc1
    v_mfma_f32_16x16x32_bf16 v[212:215], a[200:203], a[240:243], v[212:215]
    ds_read_b64_tr_b16 v[46:47], v35 offset:53504
    v_cvt_pk_bf16_f32 v81, v90, v91
    v_mfma_f32_16x16x32_bf16 v[216:219], a[208:211], a[240:243], v[216:219]
    buffer_load_dwordx4 a[172:175], v10, s[16:19], s54 offen offset:1024 sc1
    v_accvgpr_read_b32 v92, a68
    v_mfma_f32_16x16x32_bf16 v[216:219], a[212:215], a[244:247], v[216:219]
    v_accvgpr_read_b32 v93, a69
    v_accvgpr_read_b32 v94, a70
    v_mfma_f32_16x16x32_bf16 v[220:223], a[220:223], a[244:247], v[220:223]
    buffer_load_dwordx4 a[176:179], v10, s[16:19], s55 offen sc1
    v_accvgpr_read_b32 v95, a71
    v_mfma_f32_16x16x32_bf16 v[220:223], a[216:219], a[240:243], v[220:223]
    v_cvt_pk_bf16_f32 v82, v92, v93
    v_cvt_pk_bf16_f32 v83, v94, v95
    v_mfma_f32_16x16x32_bf16 v[236:239], a[216:219], a[248:251], v[236:239]
    buffer_load_dwordx4 a[180:183], v10, s[16:19], s55 offen offset:1024 sc1
    v_accvgpr_read_b32 v88, a72
    s_waitcnt lgkmcnt(0)
    v_mfma_f32_16x16x32_bf16 v[236:239], a[220:223], a[252:255], v[236:239]
    v_accvgpr_read_b32 v89, a73
    v_accvgpr_read_b32 v90, a74
    v_mfma_f32_16x16x32_bf16 v[232:235], a[212:215], a[252:255], v[232:235]
    buffer_load_dwordx4 a[184:187], v10, s[16:19], s56 offen sc1
    v_accvgpr_read_b32 v91, a75
    v_mfma_f32_16x16x32_bf16 v[232:235], a[208:211], a[248:251], v[232:235]
    v_cvt_pk_bf16_f32 v84, v88, v89
    v_cvt_pk_bf16_f32 v85, v90, v91
    v_mfma_f32_16x16x32_bf16 v[228:231], a[200:203], a[248:251], v[228:231]
    buffer_load_dwordx4 a[188:191], v10, s[16:19], s56 offen offset:1024 sc1
    v_accvgpr_read_b32 v92, a76
    v_mfma_f32_16x16x32_bf16 v[228:231], a[204:207], a[252:255], v[228:231]
    v_accvgpr_read_b32 v93, a77
    v_accvgpr_read_b32 v94, a78
    v_mfma_f32_16x16x32_bf16 v[224:227], a[196:199], a[252:255], v[224:227]
    v_accvgpr_read_b32 v95, a79
    v_cvt_pk_bf16_f32 v86, v92, v93
    v_mfma_f32_16x16x32_bf16 v[224:227], a[192:195], a[248:251], v[224:227]
    v_cvt_pk_bf16_f32 v87, v94, v95
    v_cvt_pk_bf16_f32 v176, v176, v177
    v_mfma_f32_16x16x32_bf16 v[240:243], a[192:195], v[40:43], v[240:243]
    v_cvt_pk_bf16_f32 v177, v178, v179
    v_cvt_pk_bf16_f32 v178, v180, v181
    v_mfma_f32_16x16x32_bf16 v[240:243], a[196:199], v[44:47], v[240:243]
    v_cvt_pk_bf16_f32 v179, v182, v183
    v_cvt_pk_bf16_f32 v180, v184, v185
    v_mfma_f32_16x16x32_bf16 v[244:247], a[204:207], v[44:47], v[244:247]
    v_cvt_pk_bf16_f32 v181, v186, v187
    v_cvt_pk_bf16_f32 v182, v188, v189
    v_mfma_f32_16x16x32_bf16 v[244:247], a[200:203], v[40:43], v[244:247]
    v_cvt_pk_bf16_f32 v183, v190, v191
    v_cvt_pk_bf16_f32 v184, v192, v193
    v_mfma_f32_16x16x32_bf16 v[248:251], a[208:211], v[40:43], v[248:251]
    v_cvt_pk_bf16_f32 v185, v194, v195
    v_cvt_pk_bf16_f32 v186, v196, v197
    v_mfma_f32_16x16x32_bf16 v[248:251], a[212:215], v[44:47], v[248:251]
    v_cvt_pk_bf16_f32 v187, v198, v199
    v_cvt_pk_bf16_f32 v188, v200, v201
    v_mfma_f32_16x16x32_bf16 v[252:255], a[220:223], v[44:47], v[252:255]
    v_cvt_pk_bf16_f32 v189, v202, v203
    v_cvt_pk_bf16_f32 v190, v204, v205
    v_mfma_f32_16x16x32_bf16 v[252:255], a[216:219], v[40:43], v[252:255]
    v_cvt_pk_bf16_f32 v191, v206, v207
    v_cvt_pk_bf16_f32 v192, v208, v209
    s_add_u32 s63, s59, 65536
    s_mov_b32 s40, 0
    v_cvt_pk_bf16_f32 v193, v210, v211
    v_cvt_pk_bf16_f32 v194, v212, v213
    v_cvt_pk_bf16_f32 v195, v214, v215
    v_cvt_pk_bf16_f32 v196, v216, v217
    v_cvt_pk_bf16_f32 v197, v218, v219
    v_cvt_pk_bf16_f32 v198, v220, v221
    v_cvt_pk_bf16_f32 v199, v222, v223
    v_cvt_pk_bf16_f32 v200, v224, v225
    v_cvt_pk_bf16_f32 v201, v226, v227
    v_cvt_pk_bf16_f32 v202, v228, v229
    v_cvt_pk_bf16_f32 v203, v230, v231
    v_cvt_pk_bf16_f32 v204, v232, v233
    v_cvt_pk_bf16_f32 v205, v234, v235
    v_cvt_pk_bf16_f32 v206, v236, v237
    v_cvt_pk_bf16_f32 v207, v238, v239
    v_cvt_pk_bf16_f32 v208, v240, v241
    v_cvt_pk_bf16_f32 v209, v242, v243
    v_cvt_pk_bf16_f32 v210, v244, v245
    v_cvt_pk_bf16_f32 v211, v246, v247
    v_cvt_pk_bf16_f32 v212, v248, v249
    v_cvt_pk_bf16_f32 v213, v250, v251
    v_cvt_pk_bf16_f32 v214, v252, v253
    v_cvt_pk_bf16_f32 v215, v254, v255
    s_waitcnt vmcnt(8)
    v_cmp_gt_i32 vcc, 0, v8
    s_cbranch_vccz B_GO_0
B_RETRY_0:
    s_add_u32 s43, s43, 1
    s_and_b32 s41, s43, s62
    s_cbranch_scc0 B_TRYC_0
    s_mov_b64 exec, 0xff
    buffer_load_dword v8, v5, s[16:19], s60 offen offset:1020 sc1
    s_mov_b64 exec, -1
    s_sub_u32 s46, s46, 1
    s_cbranch_scc1 DONE
    s_waitcnt vmcnt(0)
    v_cmp_gt_i32 vcc, 0, v8
    s_cbranch_vccnz B_RETRY_0
    buffer_load_dwordx4 a[160:163], v10, s[16:19], s53 offen sc1
    buffer_load_dwordx4 a[164:167], v10, s[16:19], s53 offen offset:1024 sc1
    buffer_load_dwordx4 a[168:171], v10, s[16:19], s54 offen sc1
    buffer_load_dwordx4 a[172:175], v10, s[16:19], s54 offen offset:1024 sc1
    buffer_load_dwordx4 a[176:179], v10, s[16:19], s55 offen sc1
    buffer_load_dwordx4 a[180:183], v10, s[16:19], s55 offen offset:1024 sc1
    buffer_load_dwordx4 a[184:187], v10, s[16:19], s56 offen sc1
    buffer_load_dwordx4 a[188:191], v10, s[16:19], s56 offen offset:1024 sc1
B_GO_0:
    s_waitcnt vmcnt(7)
    v_mfma_f32_16x16x32_bf16 v[216:219], v[96:99], a[160:163], 0
    v_accvgpr_read_b32 v40, a80
    v_accvgpr_read_b32 v41, a81
    v_accvgpr_read_b32 v42, a82
    v_mfma_f32_16x16x32_bf16 v[224:227], v[104:107], a[160:163], 0
    v_accvgpr_read_b32 v43, a83
    v_cvt_pk_bf16_f32 v136, v40, v41
    v_mfma_f32_16x16x32_bf16 v[232:235], v[112:115], a[160:163], 0
    v_cvt_pk_bf16_f32 v137, v42, v43
    v_accvgpr_read_b32 v44, a84
    v_mfma_f32_16x16x32_bf16 v[240:243], v[120:123], a[160:163], 0
    v_accvgpr_read_b32 v45, a85
    v_accvgpr_read_b32 v46, a86
    v_mfma_f32_16x16x32_bf16 v[248:251], v[128:131], a[160:163], 0
    v_accvgpr_read_b32 v47, a87
    v_cvt_pk_bf16_f32 v138, v44, v45
    s_waitcnt vmcnt(6)
    v_mfma_f32_16x16x32_bf16 v[220:223], v[96:99], a[164:167], 0
    v_cvt_pk_bf16_f32 v139, v46, v47
    v_accvgpr_read_b32 v40, a96
    v_mfma_f32_16x16x32_bf16 v[228:231], v[104:107], a[164:167], 0
    v_accvgpr_read_b32 v41, a97
    v_accvgpr_read_b32 v42, a98
    v_mfma_f32_16x16x32_bf16 v[236:239], v[112:115], a[164:167], 0
    v_accvgpr_read_b32 v43, a99
    v_cvt_pk_bf16_f32 v144, v40, v41
    v_cvt_pk_bf16_f32 v145, v42, v43
    v_mfma_f32_16x16x32_bf16 v[244:247], v[120:123], a[164:167], 0
    v_accvgpr_read_b32 v44, a100
    v_accvgpr_read_b32 v45, a101
    v_mfma_f32_16x16x32_bf16 v[252:255], v[128:131], a[164:167], 0
    v_accvgpr_read_b32 v46, a102
    v_accvgpr_read_b32 v47, a103
    s_waitcnt vmcnt(5)
    v_mfma_f32_16x16x32_bf16 v[216:219], v[48:51], a[168:171], v[216:219]
    v_cvt_pk_bf16_f32 v146, v44, v45
    v_cvt_pk_bf16_f32 v147, v46, v47
    v_mfma_f32_16x16x32_bf16 v[224:227], v[56:59], a[168:171], v[224:227]
    v_accvgpr_read_b32 v40, a112
    v_accvgpr_read_b32 v41, a113
    v_mfma_f32_16x16x32_bf16 v[232:235], v[64:67], a[168:171], v[232:235]
    v_accvgpr_read_b32 v42, a114
    v_accvgpr_read_b32 v43, a115
    v_mfma_f32_16x16x32_bf16 v[240:243], v[72:75], a[168:171], v[240:243]
    v_cvt_pk_bf16_f32 v152, v40, v41
    v_cvt_pk_bf16_f32 v153, v42, v43
    v_mfma_f32_16x16x32_bf16 v[248:251], v[80:83], a[168:171], v[248:251]
    v_accvgpr_read_b32 v44, a116
    v_accvgpr_read_b32 v45, a117
    v_accvgpr_read_b32 v46, a118
    s_waitcnt vmcnt(4)
    v_mfma_f32_16x16x32_bf16 v[220:223], v[48:51], a[172:175], v[220:223]
    v_accvgpr_read_b32 v47, a119
    v_cvt_pk_bf16_f32 v154, v44, v45
    v_mfma_f32_16x16x32_bf16 v[228:231], v[56:59], a[172:175], v[228:231]
    v_cvt_pk_bf16_f32 v155, v46, v47
    v_accvgpr_read_b32 v40, a128
    v_mfma_f32_16x16x32_bf16 v[236:239], v[64:67], a[172:175], v[236:239]
    v_accvgpr_read_b32 v41, a129
    v_accvgpr_read_b32 v42, a130
    v_mfma_f32_16x16x32_bf16 v[244:247], v[72:75], a[172:175], v[244:247]
    v_accvgpr_read_b32 v43, a131
    v_cvt_pk_bf16_f32 v160, v40, v41
    v_mfma_f32_16x16x32_bf16 v[252:255], v[80:83], a[172:175], v[252:255]
    v_cvt_pk_bf16_f32 v161, v42, v43
    v_accvgpr_read_b32 v44, a132
    s_waitcnt vmcnt(3)
    v_mfma_f32_16x16x32_bf16 v[216:219], v[136:139], a[176:179], v[216:219]
    s_mov_b64 exec, 0xff
    buffer_load_dword v9, v5, s[16:19], s61 offen offset:1020 sc1
    s_mov_b64 exec, -1
    v_accvgpr_read_b32 v45, a133
    v_accvgpr_read_b32 v46, a134
    s_waitcnt vmcnt(3)
    v_mfma_f32_16x16x32_bf16 v[220:223], v[136:139], a[180:183], v[220:223]
    v_accvgpr_read_b32 v47, a135
    v_cvt_pk_bf16_f32 v162, v44, v45
    v_cvt_pk_bf16_f32 v163, v46, v47
    s_waitcnt vmcnt(2)
    v_mfma_f32_16x16x32_bf16 v[216:219], v[176:179], a[184:187], v[216:219]
    buffer_load_dwordx4 a[192:195], v11, s[16:19], s53 offen sc1
    v_accvgpr_read_b32 v40, a144
    v_accvgpr_read_b32 v41, a145
    s_waitcnt vmcnt(2)
    v_mfma_f32_16x16x32_bf16 v[220:223], v[176:179], a[188:191], v[220:223]
    v_accvgpr_read_b32 v42, a146
    v_accvgpr_read_b32 v43, a147
    v_mfma_f32_16x16x32_bf16 v[224:227], v[144:147], a[176:179], v[224:227]
    buffer_load_dwordx4 a[196:199], v11, s[16:19], s53 offen offset:1024 sc1
    v_cvt_pk_bf16_f32 v168, v40, v41
    v_cvt_pk_bf16_f32 v169, v42, v43
    v_mfma_f32_16x16x32_bf16 v[228:231], v[144:147], a[180:183], v[228:231]
    v_accvgpr_read_b32 v44, a148
    v_accvgpr_read_b32 v45, a149
    v_mfma_f32_16x16x32_bf16 v[224:227], v[184:187], a[184:187], v[224:227]
    buffer_load_dwordx4 a[200:203], v11, s[16:19], s54 offen sc1
    v_accvgpr_read_b32 v46, a150
    v_accvgpr_read_b32 v47, a151
    v_mfma_f32_16x16x32_bf16 v[228:231], v[184:187], a[188:191], v[228:231]
    v_cvt_pk_bf16_f32 v170, v44, v45
    v_cvt_pk_bf16_f32 v171, v46, v47
    v_mfma_f32_16x16x32_bf16 v[232:235], v[152:155], a[176:179], v[232:235]
    buffer_load_dwordx4 a[204:207], v11, s[16:19], s54 offen offset:1024 sc1
    v_mfma_f32_16x16x32_bf16 v[236:239], v[152:155], a[180:183], v[236:239]
    v_mfma_f32_16x16x32_bf16 v[232:235], v[192:195], a[184:187], v[232:235]
    buffer_load_dwordx4 a[208:211], v11, s[16:19], s55 offen sc1
    v_mfma_f32_16x16x32_bf16 v[236:239], v[192:195], a[188:191], v[236:239]
    v_cmp_u_f32 vcc, v216, v220
    v_mfma_f32_16x16x32_bf16 v[240:243], v[160:163], a[176:179], v[240:243]
    buffer_load_dwordx4 a[212:215], v11, s[16:19], s55 offen offset:1024 sc1
    s_cbranch_vccnz B_CHK_0
B_OK_0:
    v_cvt_pk_bf16_f32 v88, v216, v217
    v_cvt_pk_bf16_f32 v89, v218, v219
    v_mfma_f32_16x16x32_bf16 v[244:247], v[160:163], a[180:183], v[244:247]
    v_cvt_pk_bf16_f32 v90, v220, v221
    v_cvt_pk_bf16_f32 v91, v222, v223
    v_mfma_f32_16x16x32_bf16 v[240:243], v[200:203], a[184:187], v[240:243]
    buffer_load_dwordx4 a[216:219], v11, s[16:19], s56 offen sc1
    v_mfma_f32_16x16x32_bf16 v[244:247], v[200:203], a[188:191], v[244:247]
    v_cvt_pk_bf16_f32 v92, v224, v225
B_PG2:
    s_cbranch_execz B_WARM_END
    v_cvt_pk_bf16_f32 v93, v226, v227
    v_mfma_f32_16x16x32_bf16 v[248:251], v[168:171], a[176:179], v[248:251]
    buffer_load_dwordx4 a[220:223], v11, s[16:19], s56 offen offset:1024 sc1
    v_cvt_pk_bf16_f32 v94, v228, v229
    v_cvt_pk_bf16_f32 v95, v230, v231
    v_mfma_f32_16x16x32_bf16 v[252:255], v[168:171], a[180:183], v[252:255]
    v_mfma_f32_16x16x32_bf16 v[248:251], v[208:211], a[184:187], v[248:251]
    v_mfma_f32_16x16x32_bf16 v[252:255], v[208:211], a[188:191], v[252:255]
    v_cvt_pk_bf16_f32 v26, v232, v233
    v_cvt_pk_bf16_f32 v27, v234, v235
    v_cvt_pk_bf16_f32 v28, v236, v237
    v_cvt_pk_bf16_f32 v29, v238, v239
    s_nop 1
    v_cvt_pk_bf16_f32 v30, v240, v241
    v_cvt_pk_bf16_f32 v31, v242, v243
    v_cvt_pk_bf16_f32 v32, v244, v245
    v_cvt_pk_bf16_f32 v33, v246, v247
    v_cvt_pk_bf16_f32 v34, v248, v249
    v_cvt_pk_bf16_f32 v35, v250, v251
    v_cvt_pk_bf16_f32 v36, v252, v253
    v_cvt_pk_bf16_f32 v37, v254, v255
    s_waitcnt vmcnt(8)
    v_cmp_gt_i32 vcc, 0, v9
    s_cbranch_vccz B_GO_1
B_RETRY_1:
    s_add_u32 s43, s43, 1
    s_and_b32 s41, s43, s62
    s_cbranch_scc0 B_TRYC_1
    s_mov_b64 exec, 0xff
    buffer_load_dword v9, v5, s[16:19], s61 offen offset:1020 sc1
    s_mov_b64 exec, -1
    buffer_load_dwordx4 a[192:195], v11, s[16:19], s53 offen sc1
    buffer_load_dwordx4 a[196:199], v11, s[16:19], s53 offen offset:1024 sc1
    buffer_load_dwordx4 a[200:203], v11, s[16:19], s54 offen sc1
    buffer_load_dwordx4 a[204:207], v11, s[16:19], s54 offen offset:1024 sc1
    buffer_load_dwordx4 a[208:211], v11, s[16:19], s55 offen sc1
    buffer_load_dwordx4 a[212:215], v11, s[16:19], s55 offen offset:1024 sc1
    buffer_load_dwordx4 a[216:219], v11, s[16:19], s56 offen sc1
    buffer_load_dwordx4 a[220:223], v11, s[16:19], s56 offen offset:1024 sc1
    s_sub_u32 s46, s46, 1
    s_cbranch_scc1 DONE
    s_waitcnt vmcnt(8)
    v_cmp_gt_i32 vcc, 0, v9
    s_cbranch_vccnz B_RETRY_1
B_GO_1:
    s_waitcnt vmcnt(7)
    v_mfma_f32_16x16x32_bf16 v[216:219], v[100:103], a[192:195], 0
    buffer_store_dwordx4 v[88:91], v13, s[16:19], s57 offen sc1
    v_accvgpr_read_b32 v40, a88
    v_accvgpr_read_b32 v41, a89
    v_accvgpr_read_b32 v42, a90
    v_mfma_f32_16x16x32_bf16 v[224:227], v[108:111], a[192:195], 0
    v_accvgpr_read_b32 v43, a91
    v_cvt_pk_bf16_f32 v140, v40, v41
    v_mfma_f32_16x16x32_bf16 v[232:235], v[116:119], a[192:195], 0
    buffer_store_dwordx4 v[92:95], v13, s[16:19], s57 offen offset:256 sc1
    v_cvt_pk_bf16_f32 v141, v42, v43
    v_accvgpr_read_b32 v44, a92
    v_mfma_f32_16x16x32_bf16 v[240:243], v[124:127], a[192:195], 0
    v_accvgpr_read_b32 v45, a93
    v_accvgpr_read_b32 v46, a94
    v_mfma_f32_16x16x32_bf16 v[248:251], v[132:135], a[192:195], 0
    buffer_store_dwordx4 v[26:29], v13, s[16:19], s57 offen offset:512 sc1
    v_accvgpr_read_b32 v47, a95
    v_cvt_pk_bf16_f32 v142, v44, v45
    s_waitcnt vmcnt(9)
    v_mfma_f32_16x16x32_bf16 v[220:223], v[100:103], a[196:199], 0
    v_cvt_pk_bf16_f32 v143, v46, v47
    v_accvgpr_read_b32 v40, a104
    v_mfma_f32_16x16x32_bf16 v[228:231], v[108:111], a[196:199], 0
    buffer_store_dwordx4 v[30:33], v13, s[16:19], s57 offen offset:768 sc1
    v_accvgpr_read_b32 v41, a105
    v_accvgpr_read_b32 v42, a106
    v_mfma_f32_16x16x32_bf16 v[236:239], v[116:119], a[196:199], 0
    v_accvgpr_read_b32 v43, a107
    v_cvt_pk_bf16_f32 v148, v40, v41
    v_cvt_pk_bf16_f32 v149, v42, v43
    v_mfma_f32_16x16x32_bf16 v[244:247], v[124:127], a[196:199], 0
    buffer_store_dwordx4 v[34:37], v13, s[16:19], s58 offen sc1
    v_accvgpr_read_b32 v44, a108
    v_accvgpr_read_b32 v45, a109
    v_mfma_f32_16x16x32_bf16 v[252:255], v[132:135], a[196:199], 0
    v_accvgpr_read_b32 v46, a110
    v_accvgpr_read_b32 v47, a111
    s_waitcnt vmcnt(10)
    v_mfma_f32_16x16x32_bf16 v[216:219], v[52:55], a[200:203], v[216:219]
    v_cvt_pk_bf16_f32 v150, v44, v45
    v_cvt_pk_bf16_f32 v151, v46, v47
    v_mfma_f32_16x16x32_bf16 v[224:227], v[60:63], a[200:203], v[224:227]
    v_accvgpr_read_b32 v40, a120
    v_accvgpr_read_b32 v41, a121
    v_mfma_f32_16x16x32_bf16 v[232:235], v[68:71], a[200:203], v[232:235]
    v_accvgpr_read_b32 v42, a122
    v_accvgpr_read_b32 v43, a123
    v_mfma_f32_16x16x32_bf16 v[240:243], v[76:79], a[200:203], v[240:243]
    v_cvt_pk_bf16_f32 v156, v40, v41
    v_cvt_pk_bf16_f32 v157, v42, v43
    v_mfma_f32_16x16x32_bf16 v[248:251], v[84:87], a[200:203], v[248:251]
    v_accvgpr_read_b32 v44, a124
    v_accvgpr_read_b32 v45, a125
    v_accvgpr_read_b32 v46, a126
    s_waitcnt vmcnt(9)
    v_mfma_f32_16x16x32_bf16 v[220:223], v[52:55], a[204:207], v[220:223]
    v_accvgpr_read_b32 v47, a127
    v_cvt_pk_bf16_f32 v158, v44, v45
    v_mfma_f32_16x16x32_bf16 v[228:231], v[60:63], a[204:207], v[228:231]
    v_cvt_pk_bf16_f32 v159, v46, v47
    v_accvgpr_read_b32 v40, a136
    v_mfma_f32_16x16x32_bf16 v[236:239], v[68:71], a[204:207], v[236:239]
    v_accvgpr_read_b32 v41, a137
    v_accvgpr_read_b32 v42, a138
    v_mfma_f32_16x16x32_bf16 v[244:247], v[76:79], a[204:207], v[244:247]
    v_accvgpr_read_b32 v43, a139
    v_cvt_pk_bf16_f32 v164, v40, v41
    v_mfma_f32_16x16x32_bf16 v[252:255], v[84:87], a[204:207], v[252:255]
    v_cvt_pk_bf16_f32 v165, v42, v43
    v_accvgpr_read_b32 v44, a140
    s_waitcnt vmcnt(8)
    v_mfma_f32_16x16x32_bf16 v[216:219], v[140:143], a[208:211], v[216:219]
    v_accvgpr_read_b32 v45, a141
    v_accvgpr_read_b32 v46, a142
    s_waitcnt vmcnt(7)
    v_mfma_f32_16x16x32_bf16 v[220:223], v[140:143], a[212:215], v[220:223]
    v_accvgpr_read_b32 v47, a143
    v_cvt_pk_bf16_f32 v166, v44, v45
    v_cvt_pk_bf16_f32 v167, v46, v47
    s_waitcnt vmcnt(6)
    v_mfma_f32_16x16x32_bf16 v[216:219], v[180:183], a[216:219], v[216:219]
    v_accvgpr_read_b32 v40, a152
    v_accvgpr_read_b32 v41, a153
    s_waitcnt vmcnt(5)
    v_mfma_f32_16x16x32_bf16 v[220:223], v[180:183], a[220:223], v[220:223]
    v_accvgpr_read_b32 v42, a154
    v_accvgpr_read_b32 v43, a155
    v_mfma_f32_16x16x32_bf16 v[224:227], v[148:151], a[208:211], v[224:227]
    v_cvt_pk_bf16_f32 v172, v40, v41
    v_cvt_pk_bf16_f32 v173, v42, v43
    v_mfma_f32_16x16x32_bf16 v[228:231], v[148:151], a[212:215], v[228:231]
    v_accvgpr_read_b32 v44, a156
    v_accvgpr_read_b32 v45, a157
    v_mfma_f32_16x16x32_bf16 v[224:227], v[188:191], a[216:219], v[224:227]
    v_accvgpr_read_b32 v46, a158
    v_accvgpr_read_b32 v47, a159
    v_mfma_f32_16x16x32_bf16 v[228:231], v[188:191], a[220:223], v[228:231]
    v_cvt_pk_bf16_f32 v174, v44, v45
    v_cvt_pk_bf16_f32 v175, v46, v47
    v_mfma_f32_16x16x32_bf16 v[232:235], v[156:159], a[208:211], v[232:235]
    v_mfma_f32_16x16x32_bf16 v[236:239], v[156:159], a[212:215], v[236:239]
    v_mfma_f32_16x16x32_bf16 v[232:235], v[196:199], a[216:219], v[232:235]
    v_mfma_f32_16x16x32_bf16 v[236:239], v[196:199], a[220:223], v[236:239]
    v_cmp_u_f32 vcc, v216, v220
    v_mfma_f32_16x16x32_bf16 v[240:243], v[164:167], a[208:211], v[240:243]
    s_cbranch_vccnz B_CHK_1
B_OK_1:
    v_cvt_pk_bf16_f32 v88, v216, v217
    v_cvt_pk_bf16_f32 v89, v218, v219
    v_mfma_f32_16x16x32_bf16 v[244:247], v[164:167], a[212:215], v[244:247]
    v_cvt_pk_bf16_f32 v90, v220, v221
    v_cvt_pk_bf16_f32 v91, v222, v223
    v_mfma_f32_16x16x32_bf16 v[240:243], v[204:207], a[216:219], v[240:243]
    buffer_store_dwordx4 v[88:91], v3, s[16:19], s57 offen sc1
    v_mfma_f32_16x16x32_bf16 v[244:247], v[204:207], a[220:223], v[244:247]
    v_cvt_pk_bf16_f32 v92, v224, v225
    v_cvt_pk_bf16_f32 v93, v226, v227
    v_mfma_f32_16x16x32_bf16 v[248:251], v[172:175], a[208:211], v[248:251]
    v_cvt_pk_bf16_f32 v94, v228, v229
    v_cvt_pk_bf16_f32 v95, v230, v231
    v_mfma_f32_16x16x32_bf16 v[252:255], v[172:175], a[212:215], v[252:255]
    buffer_store_dwordx4 v[92:95], v3, s[16:19], s57 offen offset:256 sc1
    v_mfma_f32_16x16x32_bf16 v[248:251], v[212:215], a[216:219], v[248:251]
    v_mfma_f32_16x16x32_bf16 v[252:255], v[212:215], a[220:223], v[252:255]
    v_cvt_pk_bf16_f32 v26, v232, v233
    v_cvt_pk_bf16_f32 v27, v234, v235
    v_cvt_pk_bf16_f32 v28, v236, v237
    v_cvt_pk_bf16_f32 v29, v238, v239
    buffer_store_dwordx4 v[26:29], v3, s[16:19], s57 offen offset:512 sc1
    s_nop 0
    v_cvt_pk_bf16_f32 v30, v240, v241
    v_cvt_pk_bf16_f32 v31, v242, v243
    v_cvt_pk_bf16_f32 v32, v244, v245
    v_cvt_pk_bf16_f32 v33, v246, v247
    buffer_store_dwordx4 v[30:33], v3, s[16:19], s57 offen offset:768 sc1
    v_cvt_pk_bf16_f32 v34, v248, v249
    v_cvt_pk_bf16_f32 v35, v250, v251
    v_cvt_pk_bf16_f32 v36, v252, v253
    v_cvt_pk_bf16_f32 v37, v254, v255
    buffer_store_dwordx4 v[34:37], v3, s[16:19], s58 offen sc1
B_FLAGS:
    s_waitcnt vmcnt(5)
    s_mov_b64 exec, 15
    buffer_store_dwordx2 v[18:19], v6, s[16:19], s59 offen sc1
    s_mov_b64 exec, -1
    s_waitcnt vmcnt(1)
    s_mov_b64 exec, 15
    buffer_store_dwordx2 v[18:19], v6, s[16:19], s63 offen sc1
    s_mov_b64 exec, -1
    s_endpgm
B_CHK_0:
    s_waitcnt vmcnt(0)
    v_mov_b32 v21, 0
    v_accvgpr_read_b32 v22, a160
    v_accvgpr_read_b32 v23, a161
    v_or3_b32 v21, v21, v22, v23
    v_accvgpr_read_b32 v22, a162
    v_accvgpr_read_b32 v23, a163
    v_or3_b32 v21, v21, v22, v23
    v_accvgpr_read_b32 v22, a164
    v_accvgpr_read_b32 v23, a165
    v_or3_b32 v21, v21, v22, v23
    v_accvgpr_read_b32 v22, a166
    v_accvgpr_read_b32 v23, a167
    v_or3_b32 v21, v21, v22, v23
    v_accvgpr_read_b32 v22, a168
    v_accvgpr_read_b32 v23, a169
    v_or3_b32 v21, v21, v22, v23
    v_accvgpr_read_b32 v22, a170
    v_accvgpr_read_b32 v23, a171
    v_or3_b32 v21, v21, v22, v23
    v_accvgpr_read_b32 v22, a172
    v_accvgpr_read_b32 v23, a173
    v_or3_b32 v21, v21, v22, v23
    v_accvgpr_read_b32 v22, a174
    v_accvgpr_read_b32 v23, a175
    v_or3_b32 v21, v21, v22, v23
    v_accvgpr_read_b32 v22, a176
    v_accvgpr_read_b32 v23, a177
    v_or3_b32 v21, v21, v22, v23
    v_accvgpr_read_b32 v22, a178
    v_accvgpr_read_b32 v23, a179
    v_or3_b32 v21, v21, v22, v23
    v_accvgpr_read_b32 v22, a180
    v_accvgpr_read_b32 v23, a181
    v_or3_b32 v21, v21, v22, v23
    v_accvgpr_read_b32 v22, a182
    v_accvgpr_read_b32 v23, a183
    v_or3_b32 v21, v21, v22, v23
    v_accvgpr_read_b32 v22, a184
    v_accvgpr_read_b32 v23, a185
    v_or3_b32 v21, v21, v22, v23
    v_accvgpr_read_b32 v22, a186
    v_accvgpr_read_b32 v23, a187
    v_or3_b32 v21, v21, v22, v23
    v_accvgpr_read_b32 v22, a188
    v_accvgpr_read_b32 v23, a189
    v_or3_b32 v21, v21, v22, v23
    v_accvgpr_read_b32 v22, a190
    v_accvgpr_read_b32 v23, a191
    v_or3_b32 v21, v21, v22, v23
    v_cmp_gt_i32 vcc, 0, v21
    s_cbranch_vccz B_OK_0
    s_branch B_RETRY_0
B_CHK_1:
    s_waitcnt vmcnt(0)
    v_mov_b32 v21, 0
    v_accvgpr_read_b32 v22, a192
    v_accvgpr_read_b32 v23, a193
    v_or3_b32 v21, v21, v22, v23
    v_accvgpr_read_b32 v22, a194
    v_accvgpr_read_b32 v23, a195
    v_or3_b32 v21, v21, v22, v23
    v_accvgpr_read_b32 v22, a196
    v_accvgpr_read_b32 v23, a197
    v_or3_b32 v21, v21, v22, v23
    v_accvgpr_read_b32 v22, a198
    v_accvgpr_read_b32 v23, a199
    v_or3_b32 v21, v21, v22, v23
    v_accvgpr_read_b32 v22, a200
    v_accvgpr_read_b32 v23, a201
    v_or3_b32 v21, v21, v22, v23
    v_accvgpr_read_b32 v22, a202
    v_accvgpr_read_b32 v23, a203
    v_or3_b32 v21, v21, v22, v23
    v_accvgpr_read_b32 v22, a204
    v_accvgpr_read_b32 v23, a205
    v_or3_b32 v21, v21, v22, v23
    v_accvgpr_read_b32 v22, a206
    v_accvgpr_read_b32 v23, a207
    v_or3_b32 v21, v21, v22, v23
    v_accvgpr_read_b32 v22, a208
    v_accvgpr_read_b32 v23, a209
    v_or3_b32 v21, v21, v22, v23
    v_accvgpr_read_b32 v22, a210
    v_accvgpr_read_b32 v23, a211
    v_or3_b32 v21, v21, v22, v23
    v_accvgpr_read_b32 v22, a212
    v_accvgpr_read_b32 v23, a213
    v_or3_b32 v21, v21, v22, v23
    v_accvgpr_read_b32 v22, a214
    v_accvgpr_read_b32 v23, a215
    v_or3_b32 v21, v21, v22, v23
    v_accvgpr_read_b32 v22, a216
    v_accvgpr_read_b32 v23, a217
    v_or3_b32 v21, v21, v22, v23
    v_accvgpr_read_b32 v22, a218
    v_accvgpr_read_b32 v23, a219
    v_or3_b32 v21, v21, v22, v23
    v_accvgpr_read_b32 v22, a220
    v_accvgpr_read_b32 v23, a221
    v_or3_b32 v21, v21, v22, v23
    v_accvgpr_read_b32 v22, a222
    v_accvgpr_read_b32 v23, a223
    v_or3_b32 v21, v21, v22, v23
    v_cmp_gt_i32 vcc, 0, v21
    s_cbranch_vccz B_OK_1
    s_branch B_RETRY_1
B_TRYC_0:
    s_sub_u32 s46, s46, 1
    s_cbranch_scc1 DONE
    buffer_load_dwordx2 v[24:25], v4, s[16:19], s52 offen offset:8 sc1
    s_waitcnt vmcnt(0)
    v_cmp_ne_u64 vcc, v[24:25], v[18:19]
    s_cbranch_vccnz B_RETRY_0
    v_add_u32 v10, 8388608, v20
    s_mov_b32 s62, 0
    buffer_load_dwordx4 a[160:163], v10, s[16:19], s53 offen sc1
    buffer_load_dwordx4 a[164:167], v10, s[16:19], s53 offen offset:1024 sc1
    buffer_load_dwordx4 a[168:171], v10, s[16:19], s54 offen sc1
    buffer_load_dwordx4 a[172:175], v10, s[16:19], s54 offen offset:1024 sc1
    buffer_load_dwordx4 a[176:179], v10, s[16:19], s55 offen sc1
    buffer_load_dwordx4 a[180:183], v10, s[16:19], s55 offen offset:1024 sc1
    buffer_load_dwordx4 a[184:187], v10, s[16:19], s56 offen sc1
    buffer_load_dwordx4 a[188:191], v10, s[16:19], s56 offen offset:1024 sc1
    s_branch B_GO_0
B_TRYC_1:
    s_sub_u32 s46, s46, 1
    s_cbranch_scc1 DONE
    buffer_load_dwordx2 v[24:25], v4, s[16:19], s52 offen offset:8 sc1
    s_waitcnt vmcnt(0)
    v_cmp_ne_u64 vcc, v[24:25], v[18:19]
    s_cbranch_vccnz B_RETRY_1
    v_add_u32 v11, 8388608, v2
    s_mov_b32 s62, 0
    buffer_load_dwordx4 a[192:195], v11, s[16:19], s53 offen sc1
    buffer_load_dwordx4 a[196:199], v11, s[16:19], s53 offen offset:1024 sc1
    buffer_load_dwordx4 a[200:203], v11, s[16:19], s54 offen sc1
    buffer_load_dwordx4 a[204:207], v11, s[16:19], s54 offen offset:1024 sc1
    buffer_load_dwordx4 a[208:211], v11, s[16:19], s55 offen sc1
    buffer_load_dwordx4 a[212:215], v11, s[16:19], s55 offen offset:1024 sc1
    buffer_load_dwordx4 a[216:219], v11, s[16:19], s56 offen sc1
    buffer_load_dwordx4 a[220:223], v11, s[16:19], s56 offen offset:1024 sc1
    s_branch B_GO_1
B_CF_SLOW:
    s_sub_u32 s46, s46, 1
    s_cbranch_scc1 DONE
    s_sleep 1
    buffer_load_dwordx2 v[24:25], v4, s[16:19], s52 offen sc1
    s_waitcnt vmcnt(0)
    s_branch B_CF
A_NON_SLOW:
    s_sub_u32 s46, s46, 1
    s_cbranch_scc1 DONE
    s_sleep 8
    v_mov_b32 v18, 0
    v_mov_b32 v19, 0
    s_mov_b64 exec, 1
    buffer_atomic_add_x2 v[18:19], off, s[24:27], 0 sc0 sc1
    s_waitcnt vmcnt(0)
    v_readfirstlane_b32 s88, v18
    v_readfirstlane_b32 s89, v19
    s_mov_b64 exec, -1
    s_nop 3
    v_mov_b32 v18, s88
    v_mov_b32 v19, s89
    s_cmp_eq_u32 s88, 0
    s_cbranch_scc1 A_NON_SLOW
    s_branch A_NON_OK
B_NON_SLOW:
    s_sub_u32 s46, s46, 1
    s_cbranch_scc1 DONE
    s_sleep 8
    v_mov_b32 v18, 0
    v_mov_b32 v19, 0
    s_mov_b64 exec, 1
    buffer_atomic_add_x2 v[18:19], off, s[24:27], 0 sc0 sc1
    s_waitcnt vmcnt(0)
    v_readfirstlane_b32 s88, v18
    v_readfirstlane_b32 s89, v19
    s_mov_b64 exec, -1
    s_nop 3
    v_mov_b32 v18, s88
    v_mov_b32 v19, s89
    s_cmp_eq_u32 s88, 0
    s_cbranch_scc1 B_NON_SLOW
    s_branch B_NON_OK
DONE:
    s_endpgm
.section .rodata,"a"
.p2align 6
.amdhsa_kernel standalone__gqa_block_cached__near_ridge_kernel
  .amdhsa_next_free_vgpr 512
  .amdhsa_next_free_sgpr 102
  .amdhsa_accum_offset 256
  .amdhsa_group_segment_fixed_size 0
  .amdhsa_kernarg_size 64
  .amdhsa_user_sgpr_count 2
  .amdhsa_user_sgpr_kernarg_segment_ptr 1
  .amdhsa_system_sgpr_workgroup_id_x 1
.end_amdhsa_kernel
```
